```python
import torch

def _softmax(x, axis=-1):
    return torch.softmax(x, dim=axis)
def _gelu(x):
    return torch.nn.functional.gelu(x, approximate="tanh")
def _silu(x):
    return torch.nn.functional.silu(x)
def _sigmoid(x):
    return torch.sigmoid(x)
def _layernorm(x, axis=-1, eps=1e-5):
    m = x.mean(dim=axis, keepdim=True)
    v = x.var(dim=axis, keepdim=True, unbiased=False)
    return (x - m) / torch.sqrt(v + eps)
def _scatter_add(tgt, idx, src, axis=0):
    return tgt.clone().index_add_(axis, idx, src)
def _segment_sum(src, seg, n):
    out = torch.zeros((n,) + src.shape[1:], dtype=src.dtype)
    return out.index_add_(0, seg, src)
def _pad(x, pw):
    flat = tuple(v for pair in reversed(pw) for v in pair)
    return torch.nn.functional.pad(x, flat)

kernel_name = 'standalone__gqa_block_cached__near_ridge'

def setup_inputs():

    _w = (lambda a: (lambda t: t.to(torch.bfloat16) if t.is_floating_point() else t)(torch.as_tensor(a)))
    B, Sq, D = 8, 96, 640
    Hq, Hkv, Sk, Dh = 32, 32, 512, 128
    assert Hq % Hkv == 0, (Hq, Hkv)
    return {
        "x": _w((lambda *s: torch.randn(*s, dtype=torch.bfloat16) * 0.8)(B, Sq, D)),
        "k_cache": _w((lambda *s: torch.randn(*s, dtype=torch.bfloat16) * 0.8)(B, Hkv, Sk, Dh)),
        "v_cache": _w((lambda *s: torch.randn(*s, dtype=torch.bfloat16) * 0.05)(B, Hkv, Sk, Dh)),
        "wq": _w((lambda *s: torch.randn(*s, dtype=torch.bfloat16) * 0.8)(D, Hq * Dh) * (D ** -0.5)),
        "wo": _w((lambda *s: torch.randn(*s, dtype=torch.bfloat16) * 0.05)(Hq * Dh, D) * ((Hq * Dh) ** -0.5)),
    }

def reference(x, k_cache, v_cache, wq, wo):
    B, Sq, D = x.shape
    Hq, Dh = 32, 128
    Hkv = k_cache.shape[1]
    rep = Hq // Hkv
    q = (lambda x, *d: x.permute(*d))((x @ wq).reshape(B, Sq, Hq, Dh), 0, 2, 1, 3)
    k = (lambda x, n, axis: torch.repeat_interleave(x, n, dim=axis))(k_cache, rep, axis=1)
    v = (lambda x, n, axis: torch.repeat_interleave(x, n, dim=axis))(v_cache, rep, axis=1)
    scores = torch.einsum("bhqd,bhkd->bhqk", q, k) * (Dh ** -0.5)
    p = _softmax(scores, axis=-1)
    o = torch.einsum("bhqk,bhkd->bhqd", p, v)
    return (lambda x, *d: x.permute(*d))(o, 0, 2, 1, 3).reshape(B, Sq, Hq * Dh) @ wo
```

```asm
; @launch kernel=attn_kernel grid=(256,1,1) block=(512,1,1) lds=163840
; @launch kernel=oproj_kernel grid=(240,1,1) block=(512,1,1) lds=131072
.amdgcn_target "amdgcn-amd-amdhsa--gfx950"
.text
.globl attn_kernel
.p2align 8
.type attn_kernel,@function
attn_kernel:
    s_cmp_ge_u32 s2, 256
    s_cbranch_scc1 L1_end
    s_load_dwordx16 s[4:19], s[0:1], 0
    v_lshrrev_b32 v2, 6, v0
    v_and_b32 v1, 63, v0
    v_mov_b32 v6, 159744
    v_readfirstlane_b32 s40, v2
    v_mov_b32 v7, 1
    s_and_b32 s43, s2, 7
    s_lshr_b32 s44, s2, 3
    s_and_b32 s42, s43, 3
    s_lshl_b32 s42, s42, 3
    s_and_b32 s45, s44, 7
    s_add_u32 s42, s42, s45
    s_lshr_b32 s41, s43, 2
    s_lshl_b32 s41, s41, 2
    s_lshr_b32 s45, s44, 3
    s_add_u32 s41, s41, s45
    s_lshl_b32 s2, s41, 5
    s_add_u32 s2, s2, s42
    s_cmp_gt_u32 s40, 2
    s_cbranch_scc0 L1_cons
    v_lshrrev_b32 v2, 4, v1
    v_and_b32 v3, 15, v1
    v_lshlrev_b32 v4, 2, v2
    v_xor_b32 v4, v4, v3
    v_lshlrev_b32 v4, 4, v4
    v_lshl_add_u32 v10, v2, 13, v4
    v_lshl_add_u32 v11, v2, 8, v4
    v_add_u32 v4, 0, v2
    v_xor_b32 v4, v4, v3
    v_lshlrev_b32 v4, 4, v4
    v_lshl_add_u32 v12, v2, 8, v4
    v_add_u32 v4, 4, v2
    v_xor_b32 v4, v4, v3
    v_lshlrev_b32 v4, 4, v4
    v_lshl_add_u32 v13, v2, 8, v4
    v_add_u32 v4, 8, v2
    v_xor_b32 v4, v4, v3
    v_lshlrev_b32 v4, 4, v4
    v_lshl_add_u32 v14, v2, 8, v4
    v_add_u32 v4, 12, v2
    v_xor_b32 v4, v4, v3
    v_lshlrev_b32 v4, 4, v4
    v_lshl_add_u32 v15, v2, 8, v4
    v_lshrrev_b32 v5, 3, v1
    v_mul_u32_u24 v5, 1280, v5
    v_and_b32 v3, 7, v1
    v_add_u32 v4, 0, v2
    v_xor_b32 v4, v4, v3
    v_lshl_add_u32 v16, v4, 4, v5
    v_add_u32 v4, 4, v2
    v_xor_b32 v4, v4, v3
    v_lshl_add_u32 v17, v4, 4, v5
    v_lshlrev_b32 v18, 4, v1
    s_lshl_b32 s45, s42, 8
    s_mul_i32 s46, s41, 122880
    s_lshl_b32 s47, s2, 17
    s_and_b32 s62, s41, 3
    s_mul_i32 s62, s62, 0
    s_and_b32 s63, s42, 7
    s_add_u32 s62, s62, s63
    s_lshr_b32 s63, s40, 2
    s_add_u32 s62, s62, s63
    s_cmp_ge_u32 s62, 10
    s_cselect_b32 s63, 10, 0
    s_sub_u32 s62, s62, s63
    s_cmp_eq_u32 s40, 7
    s_cbranch_scc1 L1_lq1
    s_cmp_eq_u32 s40, 4
    s_cbranch_scc1 L1_lk0
    s_cmp_eq_u32 s40, 5
    s_cbranch_scc1 L1_lk1
    s_cmp_eq_u32 s40, 6
    s_cbranch_scc1 L1_lk2
    s_branch L1_lq0
L1_cons:
    s_mov_b32 s43, s40
    s_cmp_lg_u32 s40, 0
    s_cbranch_scc1 L1_noinit
    v_mov_b32 v2, 0
    v_mov_b32 v3, 0
    v_lshl_add_u32 v4, v1, 3, v6
    ds_write_b64 v4, v[2:3]
    s_waitcnt lgkmcnt(0)
L1_noinit:
    s_waitcnt lgkmcnt(0)
    s_mov_b32 s20, s4
    s_and_b32 s21, s5, 0xffff
    s_mov_b32 s22, 983040
    s_mov_b32 s23, 0x00020000
    s_mov_b32 s24, s6
    s_and_b32 s25, s7, 0xffff
    s_mov_b32 s26, 33554432
    s_mov_b32 s27, 0x00020000
    s_mov_b32 s28, s8
    s_and_b32 s29, s9, 0xffff
    s_mov_b32 s30, 33554432
    s_mov_b32 s31, 0x00020000
    s_mov_b32 s32, s10
    s_and_b32 s33, s11, 0xffff
    s_mov_b32 s34, 5242880
    s_mov_b32 s35, 0x00020000
    s_mov_b32 s36, s18
    s_and_b32 s37, s19, 0xffff
    s_mov_b32 s38, 6291456
    s_mov_b32 s39, 0x00020000
    v_lshrrev_b32 v2, 5, v1
    v_bfe_u32 v3, v1, 2, 2
    v_and_b32 v4, 3, v1
    v_bfe_u32 v5, v1, 4, 1
    v_and_b32 v8, 1, v4
    v_lshrrev_b32 v9, 1, v4
    v_lshl_or_b32 v8, v8, 1, v9
    v_lshl_add_u32 v9, v2, 3, v3
    v_lshlrev_b32 v9, 8, v9
    v_lshl_add_u32 v9, v5, 5, v9
    v_lshl_add_u32 v9, v8, 3, v9
    v_xor_b32 v8, 0, v3
    v_lshl_add_u32 v10, v8, 6, v9
    v_xor_b32 v8, 1, v3
    v_lshl_add_u32 v11, v8, 6, v9
    v_xor_b32 v8, 2, v3
    v_lshl_add_u32 v12, v8, 6, v9
    v_xor_b32 v8, 3, v3
    v_lshl_add_u32 v13, v8, 6, v9
    v_and_b32 v4, 31, v1
    s_lshl_b32 s45, s43, 12
    v_bfe_u32 v5, v1, 1, 3
    v_xor_b32 v5, v5, v2
    v_lshlrev_b32 v9, 7, v4
    v_add_u32 v9, s45, v9
    v_xor_b32 v8, 0, v5
    v_lshl_add_u32 v14, v8, 4, v9
    v_xor_b32 v8, 2, v5
    v_lshl_add_u32 v15, v8, 4, v9
    v_xor_b32 v8, 4, v5
    v_lshl_add_u32 v16, v8, 4, v9
    v_xor_b32 v8, 6, v5
    v_lshl_add_u32 v17, v8, 4, v9
    s_mov_b32 s46, 475324864
    s_mov_b32 s47, 118831216
    s_mov_b32 s48, 543498948
    s_mov_b32 s49, 135874737
    v_mov_b32 v64, 0
    v_mov_b32 v65, 0
    v_mov_b32 v66, 0
    v_mov_b32 v67, 0
    v_mov_b32 v68, 0
    v_mov_b32 v69, 0
    v_mov_b32 v70, 0
    v_mov_b32 v71, 0
    v_mov_b32 v72, 0
    v_mov_b32 v73, 0
    v_mov_b32 v74, 0
    v_mov_b32 v75, 0
    v_mov_b32 v76, 0
    v_mov_b32 v77, 0
    v_mov_b32 v78, 0
    v_mov_b32 v79, 0
    v_mov_b32 v80, 0
    v_mov_b32 v81, 0
    v_mov_b32 v82, 0
    v_mov_b32 v83, 0
    v_mov_b32 v84, 0
    v_mov_b32 v85, 0
    v_mov_b32 v86, 0
    v_mov_b32 v87, 0
    v_mov_b32 v88, 0
    v_mov_b32 v89, 0
    v_mov_b32 v90, 0
    v_mov_b32 v91, 0
    v_mov_b32 v92, 0
    v_mov_b32 v93, 0
    v_mov_b32 v94, 0
    v_mov_b32 v95, 0
    v_mov_b32 v96, 0
    v_mov_b32 v97, 0
    v_mov_b32 v98, 0
    v_mov_b32 v99, 0
    v_mov_b32 v100, 0
    v_mov_b32 v101, 0
    v_mov_b32 v102, 0
    v_mov_b32 v103, 0
    v_mov_b32 v104, 0
    v_mov_b32 v105, 0
    v_mov_b32 v106, 0
    v_mov_b32 v107, 0
    v_mov_b32 v108, 0
    v_mov_b32 v109, 0
    v_mov_b32 v110, 0
    v_mov_b32 v111, 0
    v_mov_b32 v112, 0
    v_mov_b32 v113, 0
    v_mov_b32 v114, 0
    v_mov_b32 v115, 0
    v_mov_b32 v116, 0
    v_mov_b32 v117, 0
    v_mov_b32 v118, 0
    v_mov_b32 v119, 0
    v_mov_b32 v120, 0
    v_mov_b32 v121, 0
    v_mov_b32 v122, 0
    v_mov_b32 v123, 0
    v_mov_b32 v124, 0
    v_mov_b32 v125, 0
    v_mov_b32 v126, 0
    v_mov_b32 v127, 0
    v_mov_b32 v31, v6
    s_mov_b32 s52, 0
    s_barrier
    s_and_b32 s53, s46, 63
    s_lshl_b32 s53, s53, 12
    s_lshr_b64 s[46:47], s[46:47], 6
    s_and_b32 s54, s48, 63
    s_lshl_b32 s54, s54, 12
    s_lshr_b64 s[48:49], s[48:49], 6
    v_add_u32 v18, s53, v10
    v_add_u32 v19, s53, v11
    v_add_u32 v20, s53, v12
    v_add_u32 v21, s53, v13
    v_add_u32 v22, s54, v14
    v_add_u32 v23, s54, v15
    v_add_u32 v24, s54, v16
    v_add_u32 v25, s54, v17
Lp_1:
    ds_read_b32 v5, v31 offset:0
    s_waitcnt lgkmcnt(0)
    v_readfirstlane_b32 s57, v5
    s_cmp_ge_u32 s57, 1
    s_cbranch_scc0 Lp_1
    ds_read_b128 v[192:195], v22
    ds_read_b64_tr_b16 v[128:129], v18 offset:0
    ds_read_b64_tr_b16 v[130:131], v18 offset:1024
    ds_read_b64_tr_b16 v[132:133], v19 offset:0
    ds_read_b64_tr_b16 v[134:135], v19 offset:1024
    ds_read_b64_tr_b16 v[136:137], v20 offset:0
    ds_read_b64_tr_b16 v[138:139], v20 offset:1024
    ds_read_b64_tr_b16 v[140:141], v21 offset:0
    ds_read_b64_tr_b16 v[142:143], v21 offset:1024
    ds_read_b128 v[196:199], v23
    ds_read_b64_tr_b16 v[144:145], v18 offset:4096
    ds_read_b64_tr_b16 v[146:147], v18 offset:5120
    ds_read_b64_tr_b16 v[148:149], v19 offset:4096
    ds_read_b64_tr_b16 v[150:151], v19 offset:5120
    ds_read_b64_tr_b16 v[152:153], v20 offset:4096
    ds_read_b64_tr_b16 v[154:155], v20 offset:5120
    ds_read_b64_tr_b16 v[156:157], v21 offset:4096
    ds_read_b64_tr_b16 v[158:159], v21 offset:5120
L1_qloop:
    s_waitcnt lgkmcnt(9)
    v_mfma_f32_32x32x16_bf16 v[64:79], v[128:131], v[192:195], v[64:79]
    v_mfma_f32_32x32x16_bf16 v[80:95], v[132:135], v[192:195], v[80:95]
    v_mfma_f32_32x32x16_bf16 v[96:111], v[136:139], v[192:195], v[96:111]
    v_mfma_f32_32x32x16_bf16 v[112:127], v[140:143], v[192:195], v[112:127]
    ds_read_b128 v[200:203], v24
    ds_read_b64_tr_b16 v[160:161], v18 offset:8192
    ds_read_b64_tr_b16 v[162:163], v18 offset:9216
    ds_read_b64_tr_b16 v[164:165], v19 offset:8192
    ds_read_b64_tr_b16 v[166:167], v19 offset:9216
    ds_read_b64_tr_b16 v[168:169], v20 offset:8192
    ds_read_b64_tr_b16 v[170:171], v20 offset:9216
    ds_read_b64_tr_b16 v[172:173], v21 offset:8192
    ds_read_b64_tr_b16 v[174:175], v21 offset:9216
    s_waitcnt lgkmcnt(9)
    v_mfma_f32_32x32x16_bf16 v[64:79], v[144:147], v[196:199], v[64:79]
    v_mfma_f32_32x32x16_bf16 v[80:95], v[148:151], v[196:199], v[80:95]
    v_mfma_f32_32x32x16_bf16 v[96:111], v[152:155], v[196:199], v[96:111]
    v_mfma_f32_32x32x16_bf16 v[112:127], v[156:159], v[196:199], v[112:127]
    ds_read_b128 v[204:207], v25
    ds_read_b64_tr_b16 v[176:177], v18 offset:12288
    ds_read_b64_tr_b16 v[178:179], v18 offset:13312
    ds_read_b64_tr_b16 v[180:181], v19 offset:12288
    ds_read_b64_tr_b16 v[182:183], v19 offset:13312
    ds_read_b64_tr_b16 v[184:185], v20 offset:12288
    ds_read_b64_tr_b16 v[186:187], v20 offset:13312
    ds_read_b64_tr_b16 v[188:189], v21 offset:12288
    ds_read_b64_tr_b16 v[190:191], v21 offset:13312
    s_waitcnt lgkmcnt(9)
    v_mfma_f32_32x32x16_bf16 v[64:79], v[160:163], v[200:203], v[64:79]
    v_mfma_f32_32x32x16_bf16 v[80:95], v[164:167], v[200:203], v[80:95]
    v_mfma_f32_32x32x16_bf16 v[96:111], v[168:171], v[200:203], v[96:111]
    v_mfma_f32_32x32x16_bf16 v[112:127], v[172:175], v[200:203], v[112:127]
    s_waitcnt lgkmcnt(0)
    s_mov_b64 exec, 1
    ds_add_u32 v31, v7 offset:128
    s_mov_b64 exec, -1
    s_and_b32 s53, s46, 63
    s_lshl_b32 s53, s53, 12
    s_lshr_b64 s[46:47], s[46:47], 6
    s_and_b32 s54, s48, 63
    s_lshl_b32 s54, s54, 12
    s_lshr_b64 s[48:49], s[48:49], 6
    v_add_u32 v18, s53, v10
    v_add_u32 v19, s53, v11
    v_add_u32 v20, s53, v12
    v_add_u32 v21, s53, v13
    v_add_u32 v22, s54, v14
    v_add_u32 v23, s54, v15
    v_add_u32 v24, s54, v16
    v_add_u32 v25, s54, v17
Lp_2:
    ds_read_b32 v5, v31 offset:4
    s_waitcnt lgkmcnt(0)
    v_readfirstlane_b32 s57, v5
    s_cmp_ge_u32 s57, 1
    s_cbranch_scc0 Lp_2
    ds_read_b128 v[192:195], v22
    ds_read_b64_tr_b16 v[128:129], v18 offset:0
    ds_read_b64_tr_b16 v[130:131], v18 offset:1024
    ds_read_b64_tr_b16 v[132:133], v19 offset:0
    ds_read_b64_tr_b16 v[134:135], v19 offset:1024
    ds_read_b64_tr_b16 v[136:137], v20 offset:0
    ds_read_b64_tr_b16 v[138:139], v20 offset:1024
    ds_read_b64_tr_b16 v[140:141], v21 offset:0
    ds_read_b64_tr_b16 v[142:143], v21 offset:1024
    v_mfma_f32_32x32x16_bf16 v[64:79], v[176:179], v[204:207], v[64:79]
    v_mfma_f32_32x32x16_bf16 v[80:95], v[180:183], v[204:207], v[80:95]
    v_mfma_f32_32x32x16_bf16 v[96:111], v[184:187], v[204:207], v[96:111]
    v_mfma_f32_32x32x16_bf16 v[112:127], v[188:191], v[204:207], v[112:127]
    ds_read_b128 v[196:199], v23
    ds_read_b64_tr_b16 v[144:145], v18 offset:4096
    ds_read_b64_tr_b16 v[146:147], v18 offset:5120
    ds_read_b64_tr_b16 v[148:149], v19 offset:4096
    ds_read_b64_tr_b16 v[150:151], v19 offset:5120
    ds_read_b64_tr_b16 v[152:153], v20 offset:4096
    ds_read_b64_tr_b16 v[154:155], v20 offset:5120
    ds_read_b64_tr_b16 v[156:157], v21 offset:4096
    ds_read_b64_tr_b16 v[158:159], v21 offset:5120
    v_add_u32 v31, 4, v31
    s_add_u32 s52, s52, 1
    s_cmp_lt_u32 s52, 9
    s_cbranch_scc1 L1_qloop
    s_waitcnt lgkmcnt(9)
    v_mfma_f32_32x32x16_bf16 v[64:79], v[128:131], v[192:195], v[64:79]
    v_mfma_f32_32x32x16_bf16 v[80:95], v[132:135], v[192:195], v[80:95]
    v_mfma_f32_32x32x16_bf16 v[96:111], v[136:139], v[192:195], v[96:111]
    v_mfma_f32_32x32x16_bf16 v[112:127], v[140:143], v[192:195], v[112:127]
    ds_read_b128 v[200:203], v24
    ds_read_b64_tr_b16 v[160:161], v18 offset:8192
    ds_read_b64_tr_b16 v[162:163], v18 offset:9216
    ds_read_b64_tr_b16 v[164:165], v19 offset:8192
    ds_read_b64_tr_b16 v[166:167], v19 offset:9216
    ds_read_b64_tr_b16 v[168:169], v20 offset:8192
    ds_read_b64_tr_b16 v[170:171], v20 offset:9216
    ds_read_b64_tr_b16 v[172:173], v21 offset:8192
    ds_read_b64_tr_b16 v[174:175], v21 offset:9216
    s_waitcnt lgkmcnt(9)
    v_mfma_f32_32x32x16_bf16 v[64:79], v[144:147], v[196:199], v[64:79]
    v_mfma_f32_32x32x16_bf16 v[80:95], v[148:151], v[196:199], v[80:95]
    v_mfma_f32_32x32x16_bf16 v[96:111], v[152:155], v[196:199], v[96:111]
    v_mfma_f32_32x32x16_bf16 v[112:127], v[156:159], v[196:199], v[112:127]
    ds_read_b128 v[204:207], v25
    ds_read_b64_tr_b16 v[176:177], v18 offset:12288
    ds_read_b64_tr_b16 v[178:179], v18 offset:13312
    ds_read_b64_tr_b16 v[180:181], v19 offset:12288
    ds_read_b64_tr_b16 v[182:183], v19 offset:13312
    ds_read_b64_tr_b16 v[184:185], v20 offset:12288
    ds_read_b64_tr_b16 v[186:187], v20 offset:13312
    ds_read_b64_tr_b16 v[188:189], v21 offset:12288
    ds_read_b64_tr_b16 v[190:191], v21 offset:13312
    s_waitcnt lgkmcnt(9)
    v_mfma_f32_32x32x16_bf16 v[64:79], v[160:163], v[200:203], v[64:79]
    v_mfma_f32_32x32x16_bf16 v[80:95], v[164:167], v[200:203], v[80:95]
    v_mfma_f32_32x32x16_bf16 v[96:111], v[168:171], v[200:203], v[96:111]
    v_mfma_f32_32x32x16_bf16 v[112:127], v[172:175], v[200:203], v[112:127]
    s_waitcnt lgkmcnt(0)
    s_mov_b64 exec, 1
    ds_add_u32 v31, v7 offset:128
    s_mov_b64 exec, -1
    v_mfma_f32_32x32x16_bf16 v[64:79], v[176:179], v[204:207], v[64:79]
    v_mfma_f32_32x32x16_bf16 v[80:95], v[180:183], v[204:207], v[80:95]
    v_mfma_f32_32x32x16_bf16 v[96:111], v[184:187], v[204:207], v[96:111]
    v_mfma_f32_32x32x16_bf16 v[112:127], v[188:191], v[204:207], v[112:127]
    v_lshrrev_b32 v2, 5, v1
    v_bfe_u32 v3, v1, 2, 2
    v_and_b32 v4, 3, v1
    v_bfe_u32 v5, v1, 4, 1
    v_lshl_add_u32 v9, v2, 2, v3
    v_lshlrev_b32 v9, 8, v9
    v_lshl_add_u32 v9, v5, 5, v9
    v_lshl_add_u32 v9, v4, 3, v9
    v_add_u32 v9, 16384, v9
    v_xor_b32 v8, 0, v3
    v_lshl_add_u32 v18, v8, 6, v9
    v_xor_b32 v8, 1, v3
    v_lshl_add_u32 v19, v8, 6, v9
    v_xor_b32 v8, 2, v3
    v_lshl_add_u32 v20, v8, 6, v9
    v_xor_b32 v8, 3, v3
    v_lshl_add_u32 v21, v8, 6, v9
    v_and_b32 v4, 31, v1
    v_and_b32 v5, 15, v1
    v_xor_b32 v5, v5, v2
    v_lshlrev_b32 v9, 8, v4
    v_add_u32 v9, 143360, v9
    v_xor_b32 v8, 0, v5
    v_lshl_add_u32 v10, v8, 4, v9
    v_xor_b32 v8, 2, v5
    v_lshl_add_u32 v11, v8, 4, v9
    v_xor_b32 v8, 4, v5
    v_lshl_add_u32 v12, v8, 4, v9
    v_xor_b32 v8, 6, v5
    v_lshl_add_u32 v13, v8, 4, v9
    v_xor_b32 v8, 8, v5
    v_lshl_add_u32 v14, v8, 4, v9
    v_xor_b32 v8, 10, v5
    v_lshl_add_u32 v15, v8, 4, v9
    v_xor_b32 v8, 12, v5
    v_lshl_add_u32 v16, v8, 4, v9
    v_xor_b32 v8, 14, v5
    v_lshl_add_u32 v17, v8, 4, v9
    s_mov_b32 s46, 543228416
    s_mov_b32 s47, 193
    s_mov_b32 s48, 134333708
    s_mov_b32 s49, 324
    s_mov_b32 s50, 143360
    s_mov_b32 s51, 16384
    v_mov_b32 v22, v6
Lp_3:
    ds_read_b32 v5, v22 offset:64
    s_waitcnt lgkmcnt(0)
    v_readfirstlane_b32 s57, v5
    s_cmp_ge_u32 s57, 1
    s_cbranch_scc0 Lp_3
    s_mov_b32 s55, 0x3e0293ee
    ds_read_b128 v[224:227], v10 offset:0
    ds_read_b128 v[228:231], v11 offset:0
    ds_read_b128 v[232:235], v12 offset:0
    ds_read_b128 v[236:239], v13 offset:0
    ds_read_b128 v[240:243], v14 offset:0
    ds_read_b128 v[244:247], v15 offset:0
    ds_read_b128 v[248:251], v16 offset:0
    ds_read_b128 v[252:255], v17 offset:0
    v_mul_f32 v64, s55, v64
    v_mul_f32 v65, s55, v65
    v_mul_f32 v66, s55, v66
    v_mul_f32 v67, s55, v67
    v_mul_f32 v68, s55, v68
    v_mul_f32 v69, s55, v69
    v_mul_f32 v70, s55, v70
    v_mul_f32 v71, s55, v71
    v_mul_f32 v72, s55, v72
    v_mul_f32 v73, s55, v73
    v_mul_f32 v74, s55, v74
    v_mul_f32 v75, s55, v75
    v_mul_f32 v76, s55, v76
    v_mul_f32 v77, s55, v77
    v_mul_f32 v78, s55, v78
    v_mul_f32 v79, s55, v79
    v_mul_f32 v80, s55, v80
    v_mul_f32 v81, s55, v81
    v_mul_f32 v82, s55, v82
    v_mul_f32 v83, s55, v83
    v_mul_f32 v84, s55, v84
    v_mul_f32 v85, s55, v85
    v_mul_f32 v86, s55, v86
    v_mul_f32 v87, s55, v87
    v_mul_f32 v88, s55, v88
    v_mul_f32 v89, s55, v89
    v_mul_f32 v90, s55, v90
    v_mul_f32 v91, s55, v91
    v_mul_f32 v92, s55, v92
    v_mul_f32 v93, s55, v93
    v_mul_f32 v94, s55, v94
    v_mul_f32 v95, s55, v95
    v_mul_f32 v96, s55, v96
    v_mul_f32 v97, s55, v97
    v_mul_f32 v98, s55, v98
    v_mul_f32 v99, s55, v99
    v_mul_f32 v100, s55, v100
    v_mul_f32 v101, s55, v101
    v_mul_f32 v102, s55, v102
    v_mul_f32 v103, s55, v103
    v_mul_f32 v104, s55, v104
    v_mul_f32 v105, s55, v105
    v_mul_f32 v106, s55, v106
    v_mul_f32 v107, s55, v107
    v_mul_f32 v108, s55, v108
    v_mul_f32 v109, s55, v109
    v_mul_f32 v110, s55, v110
    v_mul_f32 v111, s55, v111
    v_mul_f32 v112, s55, v112
    v_mul_f32 v113, s55, v113
    v_mul_f32 v114, s55, v114
    v_mul_f32 v115, s55, v115
    v_mul_f32 v116, s55, v116
    v_mul_f32 v117, s55, v117
    v_mul_f32 v118, s55, v118
    v_mul_f32 v119, s55, v119
    v_mul_f32 v120, s55, v120
    v_mul_f32 v121, s55, v121
    v_mul_f32 v122, s55, v122
    v_mul_f32 v123, s55, v123
    v_mul_f32 v124, s55, v124
    v_mul_f32 v125, s55, v125
    v_mul_f32 v126, s55, v126
    v_mul_f32 v127, s55, v127
    v_cvt_pk_bf16_f32 v32, v64, v65
    v_cvt_pk_bf16_f32 v33, v66, v67
    v_cvt_pk_bf16_f32 v34, v68, v69
    v_cvt_pk_bf16_f32 v35, v70, v71
    v_cvt_pk_bf16_f32 v36, v72, v73
    v_cvt_pk_bf16_f32 v37, v74, v75
    v_cvt_pk_bf16_f32 v38, v76, v77
    v_cvt_pk_bf16_f32 v39, v78, v79
    v_cvt_pk_bf16_f32 v40, v80, v81
    v_cvt_pk_bf16_f32 v41, v82, v83
    v_cvt_pk_bf16_f32 v42, v84, v85
    v_cvt_pk_bf16_f32 v43, v86, v87
    v_cvt_pk_bf16_f32 v44, v88, v89
    v_cvt_pk_bf16_f32 v45, v90, v91
    v_cvt_pk_bf16_f32 v46, v92, v93
    v_cvt_pk_bf16_f32 v47, v94, v95
    v_cvt_pk_bf16_f32 v48, v96, v97
    v_cvt_pk_bf16_f32 v49, v98, v99
    v_cvt_pk_bf16_f32 v50, v100, v101
    v_cvt_pk_bf16_f32 v51, v102, v103
    v_cvt_pk_bf16_f32 v52, v104, v105
    v_cvt_pk_bf16_f32 v53, v106, v107
    v_cvt_pk_bf16_f32 v54, v108, v109
    v_cvt_pk_bf16_f32 v55, v110, v111
    v_cvt_pk_bf16_f32 v56, v112, v113
    v_cvt_pk_bf16_f32 v57, v114, v115
    v_cvt_pk_bf16_f32 v58, v116, v117
    v_cvt_pk_bf16_f32 v59, v118, v119
    v_cvt_pk_bf16_f32 v60, v120, v121
    v_cvt_pk_bf16_f32 v61, v122, v123
    v_cvt_pk_bf16_f32 v62, v124, v125
    v_cvt_pk_bf16_f32 v63, v126, v127
    v_mov_b32 v64, 0
    v_mov_b32 v65, 0
    v_mov_b32 v66, 0
    v_mov_b32 v67, 0
    v_mov_b32 v68, 0
    v_mov_b32 v69, 0
    v_mov_b32 v70, 0
    v_mov_b32 v71, 0
    v_mov_b32 v72, 0
    v_mov_b32 v73, 0
    v_mov_b32 v74, 0
    v_mov_b32 v75, 0
    v_mov_b32 v76, 0
    v_mov_b32 v77, 0
    v_mov_b32 v78, 0
    v_mov_b32 v79, 0
    v_mov_b32 v80, 0
    v_mov_b32 v81, 0
    v_mov_b32 v82, 0
    v_mov_b32 v83, 0
    v_mov_b32 v84, 0
    v_mov_b32 v85, 0
    v_mov_b32 v86, 0
    v_mov_b32 v87, 0
    v_mov_b32 v88, 0
    v_mov_b32 v89, 0
    v_mov_b32 v90, 0
    v_mov_b32 v91, 0
    v_mov_b32 v92, 0
    v_mov_b32 v93, 0
    v_mov_b32 v94, 0
    v_mov_b32 v95, 0
    v_mov_b32 v96, 0
    v_mov_b32 v97, 0
    v_mov_b32 v98, 0
    v_mov_b32 v99, 0
    v_mov_b32 v100, 0
    v_mov_b32 v101, 0
    v_mov_b32 v102, 0
    v_mov_b32 v103, 0
    v_mov_b32 v104, 0
    v_mov_b32 v105, 0
    v_mov_b32 v106, 0
    v_mov_b32 v107, 0
    v_mov_b32 v108, 0
    v_mov_b32 v109, 0
    v_mov_b32 v110, 0
    v_mov_b32 v111, 0
    v_mov_b32 v112, 0
    v_mov_b32 v113, 0
    v_mov_b32 v114, 0
    v_mov_b32 v115, 0
    v_mov_b32 v116, 0
    v_mov_b32 v117, 0
    v_mov_b32 v118, 0
    v_mov_b32 v119, 0
    v_mov_b32 v120, 0
    v_mov_b32 v121, 0
    v_mov_b32 v122, 0
    v_mov_b32 v123, 0
    v_mov_b32 v124, 0
    v_mov_b32 v125, 0
    v_mov_b32 v126, 0
    v_mov_b32 v127, 0
    v_mov_b32 v208, 0
    v_mov_b32 v209, 0
    v_mov_b32 v210, 0
    v_mov_b32 v211, 0
    v_mov_b32 v212, 0
    v_mov_b32 v213, 0
    v_mov_b32 v214, 0
    v_mov_b32 v215, 0
    v_mov_b32 v216, 0
    v_mov_b32 v217, 0
    v_mov_b32 v218, 0
    v_mov_b32 v219, 0
    v_mov_b32 v220, 0
    v_mov_b32 v221, 0
    v_mov_b32 v222, 0
    v_mov_b32 v223, 0
    v_mov_b32 v23, 0
    s_mov_b32 s55, 0xff800000
    s_mov_b32 s59, 0xff800000
    s_mov_b32 s52, 0
    s_waitcnt lgkmcnt(7)
    v_mfma_f32_32x32x16_bf16 v[128:143], v[224:227], v[32:35], v[208:223]
    ds_read_b128 v[224:227], v10 offset:8192
    s_waitcnt lgkmcnt(7)
    v_mfma_f32_32x32x16_bf16 v[128:143], v[228:231], v[36:39], v[128:143]
    ds_read_b32 v29, v22 offset:68
    ds_read_b128 v[228:231], v11 offset:8192
    s_waitcnt lgkmcnt(8)
    v_mfma_f32_32x32x16_bf16 v[128:143], v[232:235], v[40:43], v[128:143]
    ds_read_b128 v[232:235], v12 offset:8192
    s_waitcnt lgkmcnt(8)
    v_mfma_f32_32x32x16_bf16 v[128:143], v[236:239], v[44:47], v[128:143]
    ds_read_b128 v[236:239], v13 offset:8192
    s_waitcnt lgkmcnt(8)
    v_mfma_f32_32x32x16_bf16 v[128:143], v[240:243], v[48:51], v[128:143]
    ds_read_b128 v[240:243], v14 offset:8192
    s_waitcnt lgkmcnt(8)
    v_mfma_f32_32x32x16_bf16 v[128:143], v[244:247], v[52:55], v[128:143]
    ds_read_b128 v[244:247], v15 offset:8192
    s_waitcnt lgkmcnt(8)
    v_mfma_f32_32x32x16_bf16 v[128:143], v[248:251], v[56:59], v[128:143]
    ds_read_b128 v[248:251], v16 offset:8192
    s_waitcnt lgkmcnt(8)
    v_mfma_f32_32x32x16_bf16 v[128:143], v[252:255], v[60:63], v[128:143]
    ds_read_b128 v[252:255], v17 offset:8192
    s_waitcnt lgkmcnt(7)
    v_readfirstlane_b32 s57, v29
    s_cmp_ge_u32 s57, 1
    s_cbranch_scc1 Lok_4
Lp_5:
    ds_read_b32 v5, v22 offset:68
    s_waitcnt lgkmcnt(0)
    v_readfirstlane_b32 s57, v5
    s_cmp_ge_u32 s57, 1
    s_cbranch_scc0 Lp_5
Lok_4:
    s_and_b32 s53, s46, 63
    s_lshl_b32 s53, s53, 12
    s_lshr_b64 s[46:47], s[46:47], 6
    s_sub_u32 s54, s53, s50
    s_mov_b32 s50, s53
    v_add_u32 v10, s54, v10
    v_add_u32 v11, s54, v11
    v_add_u32 v12, s54, v12
    v_add_u32 v13, s54, v13
    v_add_u32 v14, s54, v14
    v_add_u32 v15, s54, v15
    v_add_u32 v16, s54, v16
    v_add_u32 v17, s54, v17
    v_mfma_f32_32x32x16_bf16 v[144:159], v[224:227], v[32:35], v[208:223]
    ds_read_b128 v[224:227], v10 offset:0
    s_waitcnt lgkmcnt(7)
    v_mfma_f32_32x32x16_bf16 v[144:159], v[228:231], v[36:39], v[144:159]
    ds_read_b128 v[228:231], v11 offset:0
    s_waitcnt lgkmcnt(7)
    v_mfma_f32_32x32x16_bf16 v[144:159], v[232:235], v[40:43], v[144:159]
    ds_read_b128 v[232:235], v12 offset:0
    s_waitcnt lgkmcnt(7)
    v_mfma_f32_32x32x16_bf16 v[144:159], v[236:239], v[44:47], v[144:159]
    ds_read_b128 v[236:239], v13 offset:0
    s_waitcnt lgkmcnt(7)
    v_mfma_f32_32x32x16_bf16 v[144:159], v[240:243], v[48:51], v[144:159]
    ds_read_b128 v[240:243], v14 offset:0
    s_waitcnt lgkmcnt(7)
    v_mfma_f32_32x32x16_bf16 v[144:159], v[244:247], v[52:55], v[144:159]
    ds_read_b128 v[244:247], v15 offset:0
    s_waitcnt lgkmcnt(7)
    v_mfma_f32_32x32x16_bf16 v[144:159], v[248:251], v[56:59], v[144:159]
    ds_read_b128 v[248:251], v16 offset:0
    s_waitcnt lgkmcnt(7)
    s_mov_b64 exec, 1
    ds_add_u32 v22, v7 offset:192
    s_mov_b64 exec, -1
    v_mfma_f32_32x32x16_bf16 v[144:159], v[252:255], v[60:63], v[144:159]
    ds_read_b128 v[252:255], v17 offset:0
    s_nop 7
    s_nop 3
    v_max3_f32 v24, v128, v129, v130
    v_max3_f32 v24, v24, v131, v132
    v_max3_f32 v24, v24, v133, v134
    v_max3_f32 v24, v24, v135, v136
    v_max3_f32 v24, v24, v137, v138
    v_max3_f32 v24, v24, v139, v140
    v_max3_f32 v24, v24, v141, v142
    v_max3_f32 v25, v143, v144, v145
    v_max3_f32 v25, v25, v146, v147
    v_max3_f32 v25, v25, v148, v149
    v_max3_f32 v25, v25, v150, v151
    v_max3_f32 v25, v25, v152, v153
    v_max3_f32 v25, v25, v154, v155
    v_max3_f32 v25, v25, v156, v157
    v_max3_f32 v25, v25, v158, v159
    v_max_f32 v24, v24, v25
    v_cmp_lt_f32 vcc, s55, v24
    s_cbranch_vccnz Lslow_6
Lback_7:
L1_aloop:
    s_waitcnt lgkmcnt(7)
    v_mfma_f32_32x32x16_bf16 v[160:175], v[224:227], v[32:35], v[208:223]
    ds_read_b128 v[224:227], v10 offset:8192
    v_exp_f32 v128, v128
    v_exp_f32 v129, v129
    s_waitcnt lgkmcnt(7)
    v_mfma_f32_32x32x16_bf16 v[160:175], v[228:231], v[36:39], v[160:175]
    ds_read_b32 v28, v22 offset:96
    ds_read_b128 v[228:231], v11 offset:8192
    v_exp_f32 v130, v130
    v_exp_f32 v131, v131
    v_cvt_pk_bf16_f32 v192, v128, v129
    s_waitcnt lgkmcnt(8)
    v_mfma_f32_32x32x16_bf16 v[160:175], v[232:235], v[40:43], v[160:175]
    ds_read_b128 v[232:235], v12 offset:8192
    v_exp_f32 v132, v132
    v_exp_f32 v133, v133
    v_cvt_pk_bf16_f32 v193, v130, v131
    s_waitcnt lgkmcnt(8)
    v_mfma_f32_32x32x16_bf16 v[160:175], v[236:239], v[44:47], v[160:175]
    ds_read_b128 v[236:239], v13 offset:8192
    v_exp_f32 v134, v134
    v_exp_f32 v135, v135
    v_cvt_pk_bf16_f32 v194, v132, v133
    s_waitcnt lgkmcnt(8)
    v_mfma_f32_32x32x16_bf16 v[160:175], v[240:243], v[48:51], v[160:175]
    ds_read_b128 v[240:243], v14 offset:8192
    v_exp_f32 v136, v136
    v_exp_f32 v137, v137
    v_cvt_pk_bf16_f32 v195, v134, v135
    s_waitcnt lgkmcnt(8)
    v_mfma_f32_32x32x16_bf16 v[160:175], v[244:247], v[52:55], v[160:175]
    ds_read_b128 v[244:247], v15 offset:8192
    v_exp_f32 v138, v138
    v_exp_f32 v139, v139
    v_cvt_pk_bf16_f32 v196, v136, v137
    s_waitcnt lgkmcnt(8)
    v_mfma_f32_32x32x16_bf16 v[160:175], v[248:251], v[56:59], v[160:175]
    ds_read_b128 v[248:251], v16 offset:8192
    v_exp_f32 v140, v140
    v_exp_f32 v141, v141
    v_cvt_pk_bf16_f32 v197, v138, v139
    s_waitcnt lgkmcnt(8)
    v_mfma_f32_32x32x16_bf16 v[160:175], v[252:255], v[60:63], v[160:175]
    ds_read_b128 v[252:255], v17 offset:8192
    v_exp_f32 v142, v142
    v_exp_f32 v143, v143
    v_cvt_pk_bf16_f32 v198, v140, v141
    s_waitcnt lgkmcnt(7)
    v_readfirstlane_b32 s57, v28
    s_cmp_ge_u32 s57, 1
    s_cbranch_scc1 Lok_8
Lp_9:
    ds_read_b32 v5, v22 offset:96
    s_waitcnt lgkmcnt(0)
    v_readfirstlane_b32 s57, v5
    s_cmp_ge_u32 s57, 1
    s_cbranch_scc0 Lp_9
Lok_8:
    v_mfma_f32_32x32x16_bf16 v[176:191], v[224:227], v[32:35], v[208:223]
    ds_read_b64_tr_b16 v[224:225], v18 offset:0
    ds_read_b64_tr_b16 v[226:227], v18 offset:2048
    v_exp_f32 v144, v144
    v_exp_f32 v145, v145
    v_cvt_pk_bf16_f32 v199, v142, v143
    s_waitcnt lgkmcnt(8)
    v_mfma_f32_32x32x16_bf16 v[176:191], v[228:231], v[36:39], v[176:191]
    ds_read_b64_tr_b16 v[228:229], v19 offset:0
    ds_read_b64_tr_b16 v[230:231], v19 offset:2048
    v_exp_f32 v146, v146
    v_exp_f32 v147, v147
    v_cvt_pk_bf16_f32 v200, v144, v145
    s_waitcnt lgkmcnt(9)
    v_mfma_f32_32x32x16_bf16 v[176:191], v[232:235], v[40:43], v[176:191]
    ds_read_b64_tr_b16 v[232:233], v20 offset:0
    ds_read_b64_tr_b16 v[234:235], v20 offset:2048
    v_exp_f32 v148, v148
    v_exp_f32 v149, v149
    v_cvt_pk_bf16_f32 v201, v146, v147
    s_waitcnt lgkmcnt(10)
    v_mfma_f32_32x32x16_bf16 v[176:191], v[236:239], v[44:47], v[176:191]
    ds_read_b64_tr_b16 v[236:237], v21 offset:0
    ds_read_b64_tr_b16 v[238:239], v21 offset:2048
    v_exp_f32 v150, v150
    v_exp_f32 v151, v151
    v_cvt_pk_bf16_f32 v202, v148, v149
    s_waitcnt lgkmcnt(11)
    v_mfma_f32_32x32x16_bf16 v[176:191], v[240:243], v[48:51], v[176:191]
    ds_read_b64_tr_b16 v[240:241], v18 offset:4096
    ds_read_b64_tr_b16 v[242:243], v18 offset:6144
    v_exp_f32 v152, v152
    v_exp_f32 v153, v153
    v_cvt_pk_bf16_f32 v203, v150, v151
    s_waitcnt lgkmcnt(12)
    v_mfma_f32_32x32x16_bf16 v[176:191], v[244:247], v[52:55], v[176:191]
    ds_read_b64_tr_b16 v[244:245], v19 offset:4096
    ds_read_b64_tr_b16 v[246:247], v19 offset:6144
    v_exp_f32 v154, v154
    v_exp_f32 v155, v155
    v_cvt_pk_bf16_f32 v204, v152, v153
    s_waitcnt lgkmcnt(13)
    v_mfma_f32_32x32x16_bf16 v[176:191], v[248:251], v[56:59], v[176:191]
    ds_read_b64_tr_b16 v[248:249], v20 offset:4096
    ds_read_b64_tr_b16 v[250:251], v20 offset:6144
    v_exp_f32 v156, v156
    v_exp_f32 v157, v157
    v_cvt_pk_bf16_f32 v205, v154, v155
    s_waitcnt lgkmcnt(14)
    s_mov_b64 exec, 1
    ds_add_u32 v22, v7 offset:196
    s_mov_b64 exec, -1
    v_mfma_f32_32x32x16_bf16 v[176:191], v[252:255], v[60:63], v[176:191]
    ds_read_b64_tr_b16 v[252:253], v21 offset:4096
    ds_read_b64_tr_b16 v[254:255], v21 offset:6144
    v_exp_f32 v158, v158
    v_exp_f32 v159, v159
    v_cvt_pk_bf16_f32 v206, v156, v157
    v_cvt_pk_bf16_f32 v207, v158, v159
    s_waitcnt lgkmcnt(14)
    v_mfma_f32_32x32x16_bf16 v[64:79], v[224:227], v[192:195], v[64:79]
    ds_read_b64_tr_b16 v[224:225], v18 offset:8192
    ds_read_b64_tr_b16 v[226:227], v18 offset:10240
    v_add_f32 v26, v128, v129
    v_add_f32 v27, v130, v131
    v_add_f32 v26, v26, v132
    v_add_f32 v27, v27, v133
    s_waitcnt lgkmcnt(14)
    v_mfma_f32_32x32x16_bf16 v[80:95], v[228:231], v[192:195], v[80:95]
    ds_read_b32 v29, v22 offset:72
    ds_read_b64_tr_b16 v[228:229], v19 offset:8192
    ds_read_b64_tr_b16 v[230:231], v19 offset:10240
    v_add_f32 v26, v26, v134
    v_add_f32 v27, v27, v135
    v_add_f32 v26, v26, v136
    v_add_f32 v27, v27, v137
    s_waitcnt lgkmcnt(15)
    v_mfma_f32_32x32x16_bf16 v[96:111], v[232:235], v[192:195], v[96:111]
    ds_read_b64_tr_b16 v[232:233], v20 offset:8192
    ds_read_b64_tr_b16 v[234:235], v20 offset:10240
    v_add_f32 v26, v26, v138
    v_add_f32 v27, v27, v139
    v_add_f32 v26, v26, v140
    v_add_f32 v27, v27, v141
    s_waitcnt lgkmcnt(15)
    v_mfma_f32_32x32x16_bf16 v[112:127], v[236:239], v[192:195], v[112:127]
    ds_read_b64_tr_b16 v[236:237], v21 offset:8192
    ds_read_b64_tr_b16 v[238:239], v21 offset:10240
    v_add_f32 v26, v26, v142
    v_add_f32 v27, v27, v143
    v_add_f32 v26, v26, v144
    v_add_f32 v27, v27, v145
    s_waitcnt lgkmcnt(15)
    v_mfma_f32_32x32x16_bf16 v[64:79], v[240:243], v[196:199], v[64:79]
    ds_read_b64_tr_b16 v[240:241], v18 offset:12288
    ds_read_b64_tr_b16 v[242:243], v18 offset:14336
    v_add_f32 v26, v26, v146
    v_add_f32 v27, v27, v147
    v_add_f32 v26, v26, v148
    v_add_f32 v27, v27, v149
    s_waitcnt lgkmcnt(15)
    v_mfma_f32_32x32x16_bf16 v[80:95], v[244:247], v[196:199], v[80:95]
    ds_read_b64_tr_b16 v[244:245], v19 offset:12288
    ds_read_b64_tr_b16 v[246:247], v19 offset:14336
    v_add_f32 v26, v26, v150
    v_add_f32 v27, v27, v151
    v_add_f32 v26, v26, v152
    v_add_f32 v27, v27, v153
    s_waitcnt lgkmcnt(15)
    v_mfma_f32_32x32x16_bf16 v[96:111], v[248:251], v[196:199], v[96:111]
    ds_read_b64_tr_b16 v[248:249], v20 offset:12288
    ds_read_b64_tr_b16 v[250:251], v20 offset:14336
    v_add_f32 v26, v26, v154
    v_add_f32 v27, v27, v155
    v_add_f32 v26, v26, v156
    v_add_f32 v27, v27, v157
    s_waitcnt lgkmcnt(15)
    v_mfma_f32_32x32x16_bf16 v[112:127], v[252:255], v[196:199], v[112:127]
    ds_read_b64_tr_b16 v[252:253], v21 offset:12288
    ds_read_b64_tr_b16 v[254:255], v21 offset:14336
    v_add_f32 v26, v26, v158
    v_add_f32 v27, v27, v159
    v_add_f32 v26, v26, v27
    v_add_f32 v23, v23, v26
    s_waitcnt lgkmcnt(14)
    v_readfirstlane_b32 s57, v29
    s_cmp_ge_u32 s57, 1
    s_cbranch_scc1 Lok_10
Lp_11:
    ds_read_b32 v5, v22 offset:72
    s_waitcnt lgkmcnt(0)
    v_readfirstlane_b32 s57, v5
    s_cmp_ge_u32 s57, 1
    s_cbranch_scc0 Lp_11
Lok_10:
    s_and_b32 s53, s46, 63
    s_lshl_b32 s53, s53, 12
    s_lshr_b64 s[46:47], s[46:47], 6
    s_sub_u32 s54, s53, s50
    s_mov_b32 s50, s53
    v_add_u32 v10, s54, v10
    v_add_u32 v11, s54, v11
    v_add_u32 v12, s54, v12
    v_add_u32 v13, s54, v13
    v_add_u32 v14, s54, v14
    v_add_u32 v15, s54, v15
    v_add_u32 v16, s54, v16
    v_add_u32 v17, s54, v17
    v_mfma_f32_32x32x16_bf16 v[64:79], v[224:227], v[200:203], v[64:79]
    ds_read_b128 v[224:227], v10 offset:0
    v_max3_f32 v24, v160, v161, v162
    v_max3_f32 v24, v24, v163, v164
    s_waitcnt lgkmcnt(13)
    v_mfma_f32_32x32x16_bf16 v[80:95], v[228:231], v[200:203], v[80:95]
    ds_read_b128 v[228:231], v11 offset:0
    v_max3_f32 v24, v24, v165, v166
    v_max3_f32 v24, v24, v167, v168
    s_waitcnt lgkmcnt(12)
    v_mfma_f32_32x32x16_bf16 v[96:111], v[232:235], v[200:203], v[96:111]
    ds_read_b128 v[232:235], v12 offset:0
    v_max3_f32 v24, v24, v169, v170
    v_max3_f32 v24, v24, v171, v172
    s_waitcnt lgkmcnt(11)
    v_mfma_f32_32x32x16_bf16 v[112:127], v[236:239], v[200:203], v[112:127]
    ds_read_b128 v[236:239], v13 offset:0
    v_max3_f32 v24, v24, v173, v174
    v_max3_f32 v25, v175, v176, v177
    s_waitcnt lgkmcnt(10)
    v_mfma_f32_32x32x16_bf16 v[64:79], v[240:243], v[204:207], v[64:79]
    ds_read_b128 v[240:243], v14 offset:0
    v_max3_f32 v25, v25, v178, v179
    v_max3_f32 v25, v25, v180, v181
    s_waitcnt lgkmcnt(9)
    v_mfma_f32_32x32x16_bf16 v[80:95], v[244:247], v[204:207], v[80:95]
    ds_read_b128 v[244:247], v15 offset:0
    v_max3_f32 v25, v25, v182, v183
    v_max3_f32 v25, v25, v184, v185
    s_waitcnt lgkmcnt(8)
    v_mfma_f32_32x32x16_bf16 v[96:111], v[248:251], v[204:207], v[96:111]
    ds_read_b128 v[248:251], v16 offset:0
    v_max3_f32 v25, v25, v186, v187
    v_max3_f32 v25, v25, v188, v189
    s_waitcnt lgkmcnt(7)
    s_mov_b64 exec, 1
    ds_add_u32 v22, v7 offset:224
    s_mov_b64 exec, -1
    v_mfma_f32_32x32x16_bf16 v[112:127], v[252:255], v[204:207], v[112:127]
    ds_read_b128 v[252:255], v17 offset:0
    v_max3_f32 v25, v25, v190, v191
    v_max_f32 v24, v24, v25
    s_and_b32 s53, s48, 63
    s_lshl_b32 s53, s53, 12
    s_lshr_b64 s[48:49], s[48:49], 6
    s_sub_u32 s56, s53, s51
    s_mov_b32 s51, s53
    v_add_u32 v18, s56, v18
    v_add_u32 v19, s56, v19
    v_add_u32 v20, s56, v20
    v_add_u32 v21, s56, v21
    v_add_u32 v22, 4, v22
    s_nop 3
    v_cmp_lt_f32 vcc, s55, v24
    s_cbranch_vccnz Lslow_12
Lback_13:
    s_waitcnt lgkmcnt(7)
    v_mfma_f32_32x32x16_bf16 v[128:143], v[224:227], v[32:35], v[208:223]
    ds_read_b128 v[224:227], v10 offset:8192
    v_exp_f32 v160, v160
    v_exp_f32 v161, v161
    s_waitcnt lgkmcnt(7)
    v_mfma_f32_32x32x16_bf16 v[128:143], v[228:231], v[36:39], v[128:143]
    ds_read_b32 v28, v22 offset:96
    ds_read_b128 v[228:231], v11 offset:8192
    v_exp_f32 v162, v162
    v_exp_f32 v163, v163
    v_cvt_pk_bf16_f32 v192, v160, v161
    s_waitcnt lgkmcnt(8)
    v_mfma_f32_32x32x16_bf16 v[128:143], v[232:235], v[40:43], v[128:143]
    ds_read_b128 v[232:235], v12 offset:8192
    v_exp_f32 v164, v164
    v_exp_f32 v165, v165
    v_cvt_pk_bf16_f32 v193, v162, v163
    s_waitcnt lgkmcnt(8)
    v_mfma_f32_32x32x16_bf16 v[128:143], v[236:239], v[44:47], v[128:143]
    ds_read_b128 v[236:239], v13 offset:8192
    v_exp_f32 v166, v166
    v_exp_f32 v167, v167
    v_cvt_pk_bf16_f32 v194, v164, v165
    s_waitcnt lgkmcnt(8)
    v_mfma_f32_32x32x16_bf16 v[128:143], v[240:243], v[48:51], v[128:143]
    ds_read_b128 v[240:243], v14 offset:8192
    v_exp_f32 v168, v168
    v_exp_f32 v169, v169
    v_cvt_pk_bf16_f32 v195, v166, v167
    s_waitcnt lgkmcnt(8)
    v_mfma_f32_32x32x16_bf16 v[128:143], v[244:247], v[52:55], v[128:143]
    ds_read_b128 v[244:247], v15 offset:8192
    v_exp_f32 v170, v170
    v_exp_f32 v171, v171
    v_cvt_pk_bf16_f32 v196, v168, v169
    s_waitcnt lgkmcnt(8)
    v_mfma_f32_32x32x16_bf16 v[128:143], v[248:251], v[56:59], v[128:143]
    ds_read_b128 v[248:251], v16 offset:8192
    v_exp_f32 v172, v172
    v_exp_f32 v173, v173
    v_cvt_pk_bf16_f32 v197, v170, v171
    s_waitcnt lgkmcnt(8)
    v_mfma_f32_32x32x16_bf16 v[128:143], v[252:255], v[60:63], v[128:143]
    ds_read_b128 v[252:255], v17 offset:8192
    v_exp_f32 v174, v174
    v_exp_f32 v175, v175
    v_cvt_pk_bf16_f32 v198, v172, v173
    s_waitcnt lgkmcnt(7)
    v_readfirstlane_b32 s57, v28
    s_cmp_ge_u32 s57, 1
    s_cbranch_scc1 Lok_14
Lp_15:
    ds_read_b32 v5, v22 offset:96
    s_waitcnt lgkmcnt(0)
    v_readfirstlane_b32 s57, v5
    s_cmp_ge_u32 s57, 1
    s_cbranch_scc0 Lp_15
Lok_14:
    v_mfma_f32_32x32x16_bf16 v[144:159], v[224:227], v[32:35], v[208:223]
    ds_read_b64_tr_b16 v[224:225], v18 offset:0
    ds_read_b64_tr_b16 v[226:227], v18 offset:2048
    v_exp_f32 v176, v176
    v_exp_f32 v177, v177
    v_cvt_pk_bf16_f32 v199, v174, v175
    s_waitcnt lgkmcnt(8)
    v_mfma_f32_32x32x16_bf16 v[144:159], v[228:231], v[36:39], v[144:159]
    ds_read_b64_tr_b16 v[228:229], v19 offset:0
    ds_read_b64_tr_b16 v[230:231], v19 offset:2048
    v_exp_f32 v178, v178
    v_exp_f32 v179, v179
    v_cvt_pk_bf16_f32 v200, v176, v177
    s_waitcnt lgkmcnt(9)
    v_mfma_f32_32x32x16_bf16 v[144:159], v[232:235], v[40:43], v[144:159]
    ds_read_b64_tr_b16 v[232:233], v20 offset:0
    ds_read_b64_tr_b16 v[234:235], v20 offset:2048
    v_exp_f32 v180, v180
    v_exp_f32 v181, v181
    v_cvt_pk_bf16_f32 v201, v178, v179
    s_waitcnt lgkmcnt(10)
    v_mfma_f32_32x32x16_bf16 v[144:159], v[236:239], v[44:47], v[144:159]
    ds_read_b64_tr_b16 v[236:237], v21 offset:0
    ds_read_b64_tr_b16 v[238:239], v21 offset:2048
    v_exp_f32 v182, v182
    v_exp_f32 v183, v183
    v_cvt_pk_bf16_f32 v202, v180, v181
    s_waitcnt lgkmcnt(11)
    v_mfma_f32_32x32x16_bf16 v[144:159], v[240:243], v[48:51], v[144:159]
    ds_read_b64_tr_b16 v[240:241], v18 offset:4096
    ds_read_b64_tr_b16 v[242:243], v18 offset:6144
    v_exp_f32 v184, v184
    v_exp_f32 v185, v185
    v_cvt_pk_bf16_f32 v203, v182, v183
    s_waitcnt lgkmcnt(12)
    v_mfma_f32_32x32x16_bf16 v[144:159], v[244:247], v[52:55], v[144:159]
    ds_read_b64_tr_b16 v[244:245], v19 offset:4096
    ds_read_b64_tr_b16 v[246:247], v19 offset:6144
    v_exp_f32 v186, v186
    v_exp_f32 v187, v187
    v_cvt_pk_bf16_f32 v204, v184, v185
    s_waitcnt lgkmcnt(13)
    v_mfma_f32_32x32x16_bf16 v[144:159], v[248:251], v[56:59], v[144:159]
    ds_read_b64_tr_b16 v[248:249], v20 offset:4096
    ds_read_b64_tr_b16 v[250:251], v20 offset:6144
    v_exp_f32 v188, v188
    v_exp_f32 v189, v189
    v_cvt_pk_bf16_f32 v205, v186, v187
    s_waitcnt lgkmcnt(14)
    s_mov_b64 exec, 1
    ds_add_u32 v22, v7 offset:196
    s_mov_b64 exec, -1
    v_mfma_f32_32x32x16_bf16 v[144:159], v[252:255], v[60:63], v[144:159]
    ds_read_b64_tr_b16 v[252:253], v21 offset:4096
    ds_read_b64_tr_b16 v[254:255], v21 offset:6144
    v_exp_f32 v190, v190
    v_exp_f32 v191, v191
    v_cvt_pk_bf16_f32 v206, v188, v189
    v_cvt_pk_bf16_f32 v207, v190, v191
    s_waitcnt lgkmcnt(14)
    v_mfma_f32_32x32x16_bf16 v[64:79], v[224:227], v[192:195], v[64:79]
    ds_read_b64_tr_b16 v[224:225], v18 offset:8192
    ds_read_b64_tr_b16 v[226:227], v18 offset:10240
    v_add_f32 v26, v160, v161
    v_add_f32 v27, v162, v163
    v_add_f32 v26, v26, v164
    v_add_f32 v27, v27, v165
    s_waitcnt lgkmcnt(14)
    v_mfma_f32_32x32x16_bf16 v[80:95], v[228:231], v[192:195], v[80:95]
    ds_read_b32 v29, v22 offset:72
    ds_read_b64_tr_b16 v[228:229], v19 offset:8192
    ds_read_b64_tr_b16 v[230:231], v19 offset:10240
    v_add_f32 v26, v26, v166
    v_add_f32 v27, v27, v167
    v_add_f32 v26, v26, v168
    v_add_f32 v27, v27, v169
    s_waitcnt lgkmcnt(15)
    v_mfma_f32_32x32x16_bf16 v[96:111], v[232:235], v[192:195], v[96:111]
    ds_read_b64_tr_b16 v[232:233], v20 offset:8192
    ds_read_b64_tr_b16 v[234:235], v20 offset:10240
    v_add_f32 v26, v26, v170
    v_add_f32 v27, v27, v171
    v_add_f32 v26, v26, v172
    v_add_f32 v27, v27, v173
    s_waitcnt lgkmcnt(15)
    v_mfma_f32_32x32x16_bf16 v[112:127], v[236:239], v[192:195], v[112:127]
    ds_read_b64_tr_b16 v[236:237], v21 offset:8192
    ds_read_b64_tr_b16 v[238:239], v21 offset:10240
    v_add_f32 v26, v26, v174
    v_add_f32 v27, v27, v175
    v_add_f32 v26, v26, v176
    v_add_f32 v27, v27, v177
    s_waitcnt lgkmcnt(15)
    v_mfma_f32_32x32x16_bf16 v[64:79], v[240:243], v[196:199], v[64:79]
    ds_read_b64_tr_b16 v[240:241], v18 offset:12288
    ds_read_b64_tr_b16 v[242:243], v18 offset:14336
    v_add_f32 v26, v26, v178
    v_add_f32 v27, v27, v179
    v_add_f32 v26, v26, v180
    v_add_f32 v27, v27, v181
    s_waitcnt lgkmcnt(15)
    v_mfma_f32_32x32x16_bf16 v[80:95], v[244:247], v[196:199], v[80:95]
    ds_read_b64_tr_b16 v[244:245], v19 offset:12288
    ds_read_b64_tr_b16 v[246:247], v19 offset:14336
    v_add_f32 v26, v26, v182
    v_add_f32 v27, v27, v183
    v_add_f32 v26, v26, v184
    v_add_f32 v27, v27, v185
    s_waitcnt lgkmcnt(15)
    v_mfma_f32_32x32x16_bf16 v[96:111], v[248:251], v[196:199], v[96:111]
    ds_read_b64_tr_b16 v[248:249], v20 offset:12288
    ds_read_b64_tr_b16 v[250:251], v20 offset:14336
    v_add_f32 v26, v26, v186
    v_add_f32 v27, v27, v187
    v_add_f32 v26, v26, v188
    v_add_f32 v27, v27, v189
    s_waitcnt lgkmcnt(15)
    v_mfma_f32_32x32x16_bf16 v[112:127], v[252:255], v[196:199], v[112:127]
    ds_read_b64_tr_b16 v[252:253], v21 offset:12288
    ds_read_b64_tr_b16 v[254:255], v21 offset:14336
    v_add_f32 v26, v26, v190
    v_add_f32 v27, v27, v191
    v_add_f32 v26, v26, v27
    v_add_f32 v23, v23, v26
    s_waitcnt lgkmcnt(14)
    v_readfirstlane_b32 s57, v29
    s_cmp_ge_u32 s57, 1
    s_cbranch_scc1 Lok_16
Lp_17:
    ds_read_b32 v5, v22 offset:72
    s_waitcnt lgkmcnt(0)
    v_readfirstlane_b32 s57, v5
    s_cmp_ge_u32 s57, 1
    s_cbranch_scc0 Lp_17
Lok_16:
    s_and_b32 s53, s46, 63
    s_lshl_b32 s53, s53, 12
    s_lshr_b64 s[46:47], s[46:47], 6
    s_sub_u32 s54, s53, s50
    s_mov_b32 s50, s53
    v_add_u32 v10, s54, v10
    v_add_u32 v11, s54, v11
    v_add_u32 v12, s54, v12
    v_add_u32 v13, s54, v13
    v_add_u32 v14, s54, v14
    v_add_u32 v15, s54, v15
    v_add_u32 v16, s54, v16
    v_add_u32 v17, s54, v17
    v_mfma_f32_32x32x16_bf16 v[64:79], v[224:227], v[200:203], v[64:79]
    ds_read_b128 v[224:227], v10 offset:0
    v_max3_f32 v24, v128, v129, v130
    v_max3_f32 v24, v24, v131, v132
    s_waitcnt lgkmcnt(13)
    v_mfma_f32_32x32x16_bf16 v[80:95], v[228:231], v[200:203], v[80:95]
    ds_read_b128 v[228:231], v11 offset:0
    v_max3_f32 v24, v24, v133, v134
    v_max3_f32 v24, v24, v135, v136
    s_waitcnt lgkmcnt(12)
    v_mfma_f32_32x32x16_bf16 v[96:111], v[232:235], v[200:203], v[96:111]
    ds_read_b128 v[232:235], v12 offset:0
    v_max3_f32 v24, v24, v137, v138
    v_max3_f32 v24, v24, v139, v140
    s_waitcnt lgkmcnt(11)
    v_mfma_f32_32x32x16_bf16 v[112:127], v[236:239], v[200:203], v[112:127]
    ds_read_b128 v[236:239], v13 offset:0
    v_max3_f32 v24, v24, v141, v142
    v_max3_f32 v25, v143, v144, v145
    s_waitcnt lgkmcnt(10)
    v_mfma_f32_32x32x16_bf16 v[64:79], v[240:243], v[204:207], v[64:79]
    ds_read_b128 v[240:243], v14 offset:0
    v_max3_f32 v25, v25, v146, v147
    v_max3_f32 v25, v25, v148, v149
    s_waitcnt lgkmcnt(9)
    v_mfma_f32_32x32x16_bf16 v[80:95], v[244:247], v[204:207], v[80:95]
    ds_read_b128 v[244:247], v15 offset:0
    v_max3_f32 v25, v25, v150, v151
    v_max3_f32 v25, v25, v152, v153
    s_waitcnt lgkmcnt(8)
    v_mfma_f32_32x32x16_bf16 v[96:111], v[248:251], v[204:207], v[96:111]
    ds_read_b128 v[248:251], v16 offset:0
    v_max3_f32 v25, v25, v154, v155
    v_max3_f32 v25, v25, v156, v157
    s_waitcnt lgkmcnt(7)
    s_mov_b64 exec, 1
    ds_add_u32 v22, v7 offset:224
    s_mov_b64 exec, -1
    v_mfma_f32_32x32x16_bf16 v[112:127], v[252:255], v[204:207], v[112:127]
    ds_read_b128 v[252:255], v17 offset:0
    v_max3_f32 v25, v25, v158, v159
    v_max_f32 v24, v24, v25
    s_and_b32 s53, s48, 63
    s_lshl_b32 s53, s53, 12
    s_lshr_b64 s[48:49], s[48:49], 6
    s_sub_u32 s56, s53, s51
    s_mov_b32 s51, s53
    v_add_u32 v18, s56, v18
    v_add_u32 v19, s56, v19
    v_add_u32 v20, s56, v20
    v_add_u32 v21, s56, v21
    v_add_u32 v22, 4, v22
    s_nop 3
    v_cmp_lt_f32 vcc, s55, v24
    s_cbranch_vccnz Lslow_18
Lback_19:
    s_add_u32 s52, s52, 1
    s_cmp_lt_u32 s52, 3
    s_cbranch_scc1 L1_aloop
    s_waitcnt lgkmcnt(7)
    v_mfma_f32_32x32x16_bf16 v[160:175], v[224:227], v[32:35], v[208:223]
    ds_read_b128 v[224:227], v10 offset:8192
    v_exp_f32 v128, v128
    v_exp_f32 v129, v129
    s_waitcnt lgkmcnt(7)
    v_mfma_f32_32x32x16_bf16 v[160:175], v[228:231], v[36:39], v[160:175]
    ds_read_b32 v28, v22 offset:96
    ds_read_b128 v[228:231], v11 offset:8192
    v_exp_f32 v130, v130
    v_exp_f32 v131, v131
    v_cvt_pk_bf16_f32 v192, v128, v129
    s_waitcnt lgkmcnt(8)
    v_mfma_f32_32x32x16_bf16 v[160:175], v[232:235], v[40:43], v[160:175]
    ds_read_b128 v[232:235], v12 offset:8192
    v_exp_f32 v132, v132
    v_exp_f32 v133, v133
    v_cvt_pk_bf16_f32 v193, v130, v131
    s_waitcnt lgkmcnt(8)
    v_mfma_f32_32x32x16_bf16 v[160:175], v[236:239], v[44:47], v[160:175]
    ds_read_b128 v[236:239], v13 offset:8192
    v_exp_f32 v134, v134
    v_exp_f32 v135, v135
    v_cvt_pk_bf16_f32 v194, v132, v133
    s_waitcnt lgkmcnt(8)
    v_mfma_f32_32x32x16_bf16 v[160:175], v[240:243], v[48:51], v[160:175]
    ds_read_b128 v[240:243], v14 offset:8192
    v_exp_f32 v136, v136
    v_exp_f32 v137, v137
    v_cvt_pk_bf16_f32 v195, v134, v135
    s_waitcnt lgkmcnt(8)
    v_mfma_f32_32x32x16_bf16 v[160:175], v[244:247], v[52:55], v[160:175]
    ds_read_b128 v[244:247], v15 offset:8192
    v_exp_f32 v138, v138
    v_exp_f32 v139, v139
    v_cvt_pk_bf16_f32 v196, v136, v137
    s_waitcnt lgkmcnt(8)
    v_mfma_f32_32x32x16_bf16 v[160:175], v[248:251], v[56:59], v[160:175]
    ds_read_b128 v[248:251], v16 offset:8192
    v_exp_f32 v140, v140
    v_exp_f32 v141, v141
    v_cvt_pk_bf16_f32 v197, v138, v139
    s_waitcnt lgkmcnt(8)
    v_mfma_f32_32x32x16_bf16 v[160:175], v[252:255], v[60:63], v[160:175]
    ds_read_b128 v[252:255], v17 offset:8192
    v_exp_f32 v142, v142
    v_exp_f32 v143, v143
    v_cvt_pk_bf16_f32 v198, v140, v141
    s_waitcnt lgkmcnt(7)
    v_readfirstlane_b32 s57, v28
    s_cmp_ge_u32 s57, 1
    s_cbranch_scc1 Lok_20
Lp_21:
    ds_read_b32 v5, v22 offset:96
    s_waitcnt lgkmcnt(0)
    v_readfirstlane_b32 s57, v5
    s_cmp_ge_u32 s57, 1
    s_cbranch_scc0 Lp_21
Lok_20:
    v_mfma_f32_32x32x16_bf16 v[176:191], v[224:227], v[32:35], v[208:223]
    ds_read_b64_tr_b16 v[224:225], v18 offset:0
    ds_read_b64_tr_b16 v[226:227], v18 offset:2048
    v_exp_f32 v144, v144
    v_exp_f32 v145, v145
    v_cvt_pk_bf16_f32 v199, v142, v143
    s_waitcnt lgkmcnt(8)
    v_mfma_f32_32x32x16_bf16 v[176:191], v[228:231], v[36:39], v[176:191]
    ds_read_b64_tr_b16 v[228:229], v19 offset:0
    ds_read_b64_tr_b16 v[230:231], v19 offset:2048
    v_exp_f32 v146, v146
    v_exp_f32 v147, v147
    v_cvt_pk_bf16_f32 v200, v144, v145
    s_waitcnt lgkmcnt(9)
    v_mfma_f32_32x32x16_bf16 v[176:191], v[232:235], v[40:43], v[176:191]
    ds_read_b64_tr_b16 v[232:233], v20 offset:0
    ds_read_b64_tr_b16 v[234:235], v20 offset:2048
    v_exp_f32 v148, v148
    v_exp_f32 v149, v149
    v_cvt_pk_bf16_f32 v201, v146, v147
    s_waitcnt lgkmcnt(10)
    v_mfma_f32_32x32x16_bf16 v[176:191], v[236:239], v[44:47], v[176:191]
    ds_read_b64_tr_b16 v[236:237], v21 offset:0
    ds_read_b64_tr_b16 v[238:239], v21 offset:2048
    v_exp_f32 v150, v150
    v_exp_f32 v151, v151
    v_cvt_pk_bf16_f32 v202, v148, v149
    s_waitcnt lgkmcnt(11)
    v_mfma_f32_32x32x16_bf16 v[176:191], v[240:243], v[48:51], v[176:191]
    ds_read_b64_tr_b16 v[240:241], v18 offset:4096
    ds_read_b64_tr_b16 v[242:243], v18 offset:6144
    v_exp_f32 v152, v152
    v_exp_f32 v153, v153
    v_cvt_pk_bf16_f32 v203, v150, v151
    s_waitcnt lgkmcnt(12)
    v_mfma_f32_32x32x16_bf16 v[176:191], v[244:247], v[52:55], v[176:191]
    ds_read_b64_tr_b16 v[244:245], v19 offset:4096
    ds_read_b64_tr_b16 v[246:247], v19 offset:6144
    v_exp_f32 v154, v154
    v_exp_f32 v155, v155
    v_cvt_pk_bf16_f32 v204, v152, v153
    s_waitcnt lgkmcnt(13)
    v_mfma_f32_32x32x16_bf16 v[176:191], v[248:251], v[56:59], v[176:191]
    ds_read_b64_tr_b16 v[248:249], v20 offset:4096
    ds_read_b64_tr_b16 v[250:251], v20 offset:6144
    v_exp_f32 v156, v156
    v_exp_f32 v157, v157
    v_cvt_pk_bf16_f32 v205, v154, v155
    s_waitcnt lgkmcnt(14)
    s_mov_b64 exec, 1
    ds_add_u32 v22, v7 offset:196
    s_mov_b64 exec, -1
    v_mfma_f32_32x32x16_bf16 v[176:191], v[252:255], v[60:63], v[176:191]
    ds_read_b64_tr_b16 v[252:253], v21 offset:4096
    ds_read_b64_tr_b16 v[254:255], v21 offset:6144
    v_exp_f32 v158, v158
    v_exp_f32 v159, v159
    v_cvt_pk_bf16_f32 v206, v156, v157
    v_cvt_pk_bf16_f32 v207, v158, v159
    s_waitcnt lgkmcnt(14)
    v_mfma_f32_32x32x16_bf16 v[64:79], v[224:227], v[192:195], v[64:79]
    ds_read_b64_tr_b16 v[224:225], v18 offset:8192
    ds_read_b64_tr_b16 v[226:227], v18 offset:10240
    v_add_f32 v26, v128, v129
    v_add_f32 v27, v130, v131
    v_add_f32 v26, v26, v132
    v_add_f32 v27, v27, v133
    s_waitcnt lgkmcnt(14)
    v_mfma_f32_32x32x16_bf16 v[80:95], v[228:231], v[192:195], v[80:95]
    ds_read_b64_tr_b16 v[228:229], v19 offset:8192
    ds_read_b64_tr_b16 v[230:231], v19 offset:10240
    v_add_f32 v26, v26, v134
    v_add_f32 v27, v27, v135
    v_add_f32 v26, v26, v136
    v_add_f32 v27, v27, v137
    s_waitcnt lgkmcnt(14)
    v_mfma_f32_32x32x16_bf16 v[96:111], v[232:235], v[192:195], v[96:111]
    ds_read_b64_tr_b16 v[232:233], v20 offset:8192
    ds_read_b64_tr_b16 v[234:235], v20 offset:10240
    v_add_f32 v26, v26, v138
    v_add_f32 v27, v27, v139
    v_add_f32 v26, v26, v140
    v_add_f32 v27, v27, v141
    s_waitcnt lgkmcnt(14)
    v_mfma_f32_32x32x16_bf16 v[112:127], v[236:239], v[192:195], v[112:127]
    ds_read_b64_tr_b16 v[236:237], v21 offset:8192
    ds_read_b64_tr_b16 v[238:239], v21 offset:10240
    v_add_f32 v26, v26, v142
    v_add_f32 v27, v27, v143
    v_add_f32 v26, v26, v144
    v_add_f32 v27, v27, v145
    s_waitcnt lgkmcnt(14)
    v_mfma_f32_32x32x16_bf16 v[64:79], v[240:243], v[196:199], v[64:79]
    ds_read_b64_tr_b16 v[240:241], v18 offset:12288
    ds_read_b64_tr_b16 v[242:243], v18 offset:14336
    v_add_f32 v26, v26, v146
    v_add_f32 v27, v27, v147
    v_add_f32 v26, v26, v148
    v_add_f32 v27, v27, v149
    s_waitcnt lgkmcnt(14)
    v_mfma_f32_32x32x16_bf16 v[80:95], v[244:247], v[196:199], v[80:95]
    ds_read_b64_tr_b16 v[244:245], v19 offset:12288
    ds_read_b64_tr_b16 v[246:247], v19 offset:14336
    v_add_f32 v26, v26, v150
    v_add_f32 v27, v27, v151
    v_add_f32 v26, v26, v152
    v_add_f32 v27, v27, v153
    s_waitcnt lgkmcnt(14)
    v_mfma_f32_32x32x16_bf16 v[96:111], v[248:251], v[196:199], v[96:111]
    ds_read_b64_tr_b16 v[248:249], v20 offset:12288
    ds_read_b64_tr_b16 v[250:251], v20 offset:14336
    v_add_f32 v26, v26, v154
    v_add_f32 v27, v27, v155
    v_add_f32 v26, v26, v156
    v_add_f32 v27, v27, v157
    s_waitcnt lgkmcnt(14)
    v_mfma_f32_32x32x16_bf16 v[112:127], v[252:255], v[196:199], v[112:127]
    ds_read_b64_tr_b16 v[252:253], v21 offset:12288
    ds_read_b64_tr_b16 v[254:255], v21 offset:14336
    v_add_f32 v26, v26, v158
    v_add_f32 v27, v27, v159
    v_add_f32 v26, v26, v27
    v_add_f32 v23, v23, v26
    s_waitcnt lgkmcnt(14)
    v_mfma_f32_32x32x16_bf16 v[64:79], v[224:227], v[200:203], v[64:79]
    v_max3_f32 v24, v160, v161, v162
    v_max3_f32 v24, v24, v163, v164
    s_waitcnt lgkmcnt(12)
    v_mfma_f32_32x32x16_bf16 v[80:95], v[228:231], v[200:203], v[80:95]
    v_max3_f32 v24, v24, v165, v166
    v_max3_f32 v24, v24, v167, v168
    s_waitcnt lgkmcnt(10)
    v_mfma_f32_32x32x16_bf16 v[96:111], v[232:235], v[200:203], v[96:111]
    v_max3_f32 v24, v24, v169, v170
    v_max3_f32 v24, v24, v171, v172
    s_waitcnt lgkmcnt(8)
    v_mfma_f32_32x32x16_bf16 v[112:127], v[236:239], v[200:203], v[112:127]
    v_max3_f32 v24, v24, v173, v174
    v_max3_f32 v25, v175, v176, v177
    s_waitcnt lgkmcnt(6)
    v_mfma_f32_32x32x16_bf16 v[64:79], v[240:243], v[204:207], v[64:79]
    v_max3_f32 v25, v25, v178, v179
    v_max3_f32 v25, v25, v180, v181
    s_waitcnt lgkmcnt(4)
    v_mfma_f32_32x32x16_bf16 v[80:95], v[244:247], v[204:207], v[80:95]
    v_max3_f32 v25, v25, v182, v183
    v_max3_f32 v25, v25, v184, v185
    s_waitcnt lgkmcnt(2)
    v_mfma_f32_32x32x16_bf16 v[96:111], v[248:251], v[204:207], v[96:111]
    v_max3_f32 v25, v25, v186, v187
    v_max3_f32 v25, v25, v188, v189
    s_waitcnt lgkmcnt(0)
    s_mov_b64 exec, 1
    ds_add_u32 v22, v7 offset:224
    s_mov_b64 exec, -1
    v_mfma_f32_32x32x16_bf16 v[112:127], v[252:255], v[204:207], v[112:127]
    v_max3_f32 v25, v25, v190, v191
    v_max_f32 v24, v24, v25
    s_and_b32 s53, s48, 63
    s_lshl_b32 s53, s53, 12
    s_lshr_b64 s[48:49], s[48:49], 6
    s_sub_u32 s56, s53, s51
    s_mov_b32 s51, s53
    v_add_u32 v18, s56, v18
    v_add_u32 v19, s56, v19
    v_add_u32 v20, s56, v20
    v_add_u32 v21, s56, v21
    v_add_u32 v22, 4, v22
    s_nop 3
    v_cmp_lt_f32 vcc, s55, v24
    s_cbranch_vccnz Lslow_22
Lback_23:
    v_exp_f32 v160, v160
    v_exp_f32 v161, v161
    v_exp_f32 v162, v162
    v_exp_f32 v163, v163
    v_cvt_pk_bf16_f32 v192, v160, v161
    v_exp_f32 v164, v164
    v_exp_f32 v165, v165
    v_cvt_pk_bf16_f32 v193, v162, v163
    v_exp_f32 v166, v166
    v_exp_f32 v167, v167
    v_cvt_pk_bf16_f32 v194, v164, v165
    v_exp_f32 v168, v168
    v_exp_f32 v169, v169
    v_cvt_pk_bf16_f32 v195, v166, v167
    v_exp_f32 v170, v170
    v_exp_f32 v171, v171
    v_cvt_pk_bf16_f32 v196, v168, v169
    v_exp_f32 v172, v172
    v_exp_f32 v173, v173
    v_cvt_pk_bf16_f32 v197, v170, v171
    v_exp_f32 v174, v174
    v_exp_f32 v175, v175
    v_cvt_pk_bf16_f32 v198, v172, v173
    v_exp_f32 v176, v176
    v_exp_f32 v177, v177
    v_cvt_pk_bf16_f32 v199, v174, v175
    v_exp_f32 v178, v178
    v_exp_f32 v179, v179
    v_cvt_pk_bf16_f32 v200, v176, v177
    v_exp_f32 v180, v180
    v_exp_f32 v181, v181
    v_cvt_pk_bf16_f32 v201, v178, v179
    v_exp_f32 v182, v182
    v_exp_f32 v183, v183
    v_cvt_pk_bf16_f32 v202, v180, v181
    v_exp_f32 v184, v184
    v_exp_f32 v185, v185
    v_cvt_pk_bf16_f32 v203, v182, v183
    v_exp_f32 v186, v186
    v_exp_f32 v187, v187
    v_cvt_pk_bf16_f32 v204, v184, v185
    v_exp_f32 v188, v188
    v_exp_f32 v189, v189
    v_cvt_pk_bf16_f32 v205, v186, v187
    v_exp_f32 v190, v190
    v_exp_f32 v191, v191
    v_cvt_pk_bf16_f32 v206, v188, v189
Lp_24:
    ds_read_b32 v5, v22 offset:96
    s_waitcnt lgkmcnt(0)
    v_readfirstlane_b32 s57, v5
    s_cmp_ge_u32 s57, 1
    s_cbranch_scc0 Lp_24
    v_cvt_pk_bf16_f32 v207, v190, v191
    ds_read_b64_tr_b16 v[224:225], v18 offset:0
    ds_read_b64_tr_b16 v[226:227], v18 offset:2048
    ds_read_b64_tr_b16 v[228:229], v19 offset:0
    ds_read_b64_tr_b16 v[230:231], v19 offset:2048
    ds_read_b64_tr_b16 v[232:233], v20 offset:0
    ds_read_b64_tr_b16 v[234:235], v20 offset:2048
    ds_read_b64_tr_b16 v[236:237], v21 offset:0
    ds_read_b64_tr_b16 v[238:239], v21 offset:2048
    ds_read_b64_tr_b16 v[240:241], v18 offset:4096
    ds_read_b64_tr_b16 v[242:243], v18 offset:6144
    ds_read_b64_tr_b16 v[244:245], v19 offset:4096
    ds_read_b64_tr_b16 v[246:247], v19 offset:6144
    ds_read_b64_tr_b16 v[248:249], v20 offset:4096
    ds_read_b64_tr_b16 v[250:251], v20 offset:6144
    ds_read_b64_tr_b16 v[252:253], v21 offset:4096
    ds_read_b64_tr_b16 v[254:255], v21 offset:6144
    s_waitcnt lgkmcnt(14)
    v_mfma_f32_32x32x16_bf16 v[64:79], v[224:227], v[192:195], v[64:79]
    ds_read_b64_tr_b16 v[224:225], v18 offset:8192
    ds_read_b64_tr_b16 v[226:227], v18 offset:10240
    v_add_f32 v26, v160, v161
    v_add_f32 v27, v162, v163
    v_add_f32 v26, v26, v164
    v_add_f32 v27, v27, v165
    s_waitcnt lgkmcnt(14)
    v_mfma_f32_32x32x16_bf16 v[80:95], v[228:231], v[192:195], v[80:95]
    ds_read_b64_tr_b16 v[228:229], v19 offset:8192
    ds_read_b64_tr_b16 v[230:231], v19 offset:10240
    v_add_f32 v26, v26, v166
    v_add_f32 v27, v27, v167
    v_add_f32 v26, v26, v168
    v_add_f32 v27, v27, v169
    s_waitcnt lgkmcnt(14)
    v_mfma_f32_32x32x16_bf16 v[96:111], v[232:235], v[192:195], v[96:111]
    ds_read_b64_tr_b16 v[232:233], v20 offset:8192
    ds_read_b64_tr_b16 v[234:235], v20 offset:10240
    v_add_f32 v26, v26, v170
    v_add_f32 v27, v27, v171
    v_add_f32 v26, v26, v172
    v_add_f32 v27, v27, v173
    s_waitcnt lgkmcnt(14)
    v_mfma_f32_32x32x16_bf16 v[112:127], v[236:239], v[192:195], v[112:127]
    ds_read_b64_tr_b16 v[236:237], v21 offset:8192
    ds_read_b64_tr_b16 v[238:239], v21 offset:10240
    v_add_f32 v26, v26, v174
    v_add_f32 v27, v27, v175
    v_add_f32 v26, v26, v176
    v_add_f32 v27, v27, v177
    s_waitcnt lgkmcnt(14)
    v_mfma_f32_32x32x16_bf16 v[64:79], v[240:243], v[196:199], v[64:79]
    ds_read_b64_tr_b16 v[240:241], v18 offset:12288
    ds_read_b64_tr_b16 v[242:243], v18 offset:14336
    v_add_f32 v26, v26, v178
    v_add_f32 v27, v27, v179
    v_add_f32 v26, v26, v180
    v_add_f32 v27, v27, v181
    s_waitcnt lgkmcnt(14)
    v_mfma_f32_32x32x16_bf16 v[80:95], v[244:247], v[196:199], v[80:95]
    ds_read_b64_tr_b16 v[244:245], v19 offset:12288
    ds_read_b64_tr_b16 v[246:247], v19 offset:14336
    v_add_f32 v26, v26, v182
    v_add_f32 v27, v27, v183
    v_add_f32 v26, v26, v184
    v_add_f32 v27, v27, v185
    s_waitcnt lgkmcnt(14)
    v_mfma_f32_32x32x16_bf16 v[96:111], v[248:251], v[196:199], v[96:111]
    ds_read_b64_tr_b16 v[248:249], v20 offset:12288
    ds_read_b64_tr_b16 v[250:251], v20 offset:14336
    v_add_f32 v26, v26, v186
    v_add_f32 v27, v27, v187
    v_add_f32 v26, v26, v188
    v_add_f32 v27, v27, v189
    s_waitcnt lgkmcnt(14)
    v_mfma_f32_32x32x16_bf16 v[112:127], v[252:255], v[196:199], v[112:127]
    ds_read_b64_tr_b16 v[252:253], v21 offset:12288
    ds_read_b64_tr_b16 v[254:255], v21 offset:14336
    v_add_f32 v26, v26, v190
    v_add_f32 v27, v27, v191
    v_add_f32 v26, v26, v27
    v_add_f32 v23, v23, v26
    s_waitcnt lgkmcnt(14)
    v_mfma_f32_32x32x16_bf16 v[64:79], v[224:227], v[200:203], v[64:79]
    s_waitcnt lgkmcnt(12)
    v_mfma_f32_32x32x16_bf16 v[80:95], v[228:231], v[200:203], v[80:95]
    s_waitcnt lgkmcnt(10)
    v_mfma_f32_32x32x16_bf16 v[96:111], v[232:235], v[200:203], v[96:111]
    s_waitcnt lgkmcnt(8)
    v_mfma_f32_32x32x16_bf16 v[112:127], v[236:239], v[200:203], v[112:127]
    s_waitcnt lgkmcnt(6)
    v_mfma_f32_32x32x16_bf16 v[64:79], v[240:243], v[204:207], v[64:79]
    s_waitcnt lgkmcnt(4)
    v_mfma_f32_32x32x16_bf16 v[80:95], v[244:247], v[204:207], v[80:95]
    s_waitcnt lgkmcnt(2)
    v_mfma_f32_32x32x16_bf16 v[96:111], v[248:251], v[204:207], v[96:111]
    s_waitcnt lgkmcnt(0)
    s_mov_b64 exec, 1
    ds_add_u32 v22, v7 offset:224
    s_mov_b64 exec, -1
    v_mfma_f32_32x32x16_bf16 v[112:127], v[252:255], v[204:207], v[112:127]
    v_mov_b32 v25, v23
    v_mov_b32 v24, v23
    s_nop 1
    v_permlane32_swap_b32 v24, v25
    v_add_f32 v24, v24, v25
    v_rcp_f32 v24, v24
    s_mul_i32 s45, s41, 3
    s_add_u32 s45, s45, s43
    s_lshl_b32 s45, s45, 18
    s_lshl_b32 s53, s42, 13
    s_add_u32 s45, s45, s53
    v_lshlrev_b32 v2, 4, v1
    s_nop 7
    v_mul_f32 v64, v64, v24
    v_mul_f32 v65, v65, v24
    v_mul_f32 v66, v66, v24
    v_mul_f32 v67, v67, v24
    v_mul_f32 v68, v68, v24
    v_mul_f32 v69, v69, v24
    v_mul_f32 v70, v70, v24
    v_mul_f32 v71, v71, v24
    v_cvt_pk_bf16_f32 v128, v64, v65
    v_cvt_pk_bf16_f32 v129, v66, v67
    v_cvt_pk_bf16_f32 v130, v68, v69
    v_cvt_pk_bf16_f32 v131, v70, v71
    buffer_store_dwordx4 v[128:131], v2, s[36:39], s45 offen offset:0 sc0 sc1
    v_mul_f32 v72, v72, v24
    v_mul_f32 v73, v73, v24
    v_mul_f32 v74, v74, v24
    v_mul_f32 v75, v75, v24
    v_mul_f32 v76, v76, v24
    v_mul_f32 v77, v77, v24
    v_mul_f32 v78, v78, v24
    v_mul_f32 v79, v79, v24
    v_cvt_pk_bf16_f32 v132, v72, v73
    v_cvt_pk_bf16_f32 v133, v74, v75
    v_cvt_pk_bf16_f32 v134, v76, v77
    v_cvt_pk_bf16_f32 v135, v78, v79
    buffer_store_dwordx4 v[132:135], v2, s[36:39], s45 offen offset:1024 sc0 sc1
    v_mul_f32 v80, v80, v24
    v_mul_f32 v81, v81, v24
    v_mul_f32 v82, v82, v24
    v_mul_f32 v83, v83, v24
    v_mul_f32 v84, v84, v24
    v_mul_f32 v85, v85, v24
    v_mul_f32 v86, v86, v24
    v_mul_f32 v87, v87, v24
    v_cvt_pk_bf16_f32 v136, v80, v81
    v_cvt_pk_bf16_f32 v137, v82, v83
    v_cvt_pk_bf16_f32 v138, v84, v85
    v_cvt_pk_bf16_f32 v139, v86, v87
    buffer_store_dwordx4 v[136:139], v2, s[36:39], s45 offen offset:2048 sc0 sc1
    v_mul_f32 v88, v88, v24
    v_mul_f32 v89, v89, v24
    v_mul_f32 v90, v90, v24
    v_mul_f32 v91, v91, v24
    v_mul_f32 v92, v92, v24
    v_mul_f32 v93, v93, v24
    v_mul_f32 v94, v94, v24
    v_mul_f32 v95, v95, v24
    v_cvt_pk_bf16_f32 v140, v88, v89
    v_cvt_pk_bf16_f32 v141, v90, v91
    v_cvt_pk_bf16_f32 v142, v92, v93
    v_cvt_pk_bf16_f32 v143, v94, v95
    buffer_store_dwordx4 v[140:143], v2, s[36:39], s45 offen offset:3072 sc0 sc1
    v_mul_f32 v96, v96, v24
    v_mul_f32 v97, v97, v24
    v_mul_f32 v98, v98, v24
    v_mul_f32 v99, v99, v24
    v_mul_f32 v100, v100, v24
    v_mul_f32 v101, v101, v24
    v_mul_f32 v102, v102, v24
    v_mul_f32 v103, v103, v24
    v_cvt_pk_bf16_f32 v144, v96, v97
    v_cvt_pk_bf16_f32 v145, v98, v99
    v_cvt_pk_bf16_f32 v146, v100, v101
    v_cvt_pk_bf16_f32 v147, v102, v103
    s_add_u32 s45, s45, 4096
    buffer_store_dwordx4 v[144:147], v2, s[36:39], s45 offen offset:0 sc0 sc1
    v_mul_f32 v104, v104, v24
    v_mul_f32 v105, v105, v24
    v_mul_f32 v106, v106, v24
    v_mul_f32 v107, v107, v24
    v_mul_f32 v108, v108, v24
    v_mul_f32 v109, v109, v24
    v_mul_f32 v110, v110, v24
    v_mul_f32 v111, v111, v24
    v_cvt_pk_bf16_f32 v148, v104, v105
    v_cvt_pk_bf16_f32 v149, v106, v107
    v_cvt_pk_bf16_f32 v150, v108, v109
    v_cvt_pk_bf16_f32 v151, v110, v111
    buffer_store_dwordx4 v[148:151], v2, s[36:39], s45 offen offset:1024 sc0 sc1
    v_mul_f32 v112, v112, v24
    v_mul_f32 v113, v113, v24
    v_mul_f32 v114, v114, v24
    v_mul_f32 v115, v115, v24
    v_mul_f32 v116, v116, v24
    v_mul_f32 v117, v117, v24
    v_mul_f32 v118, v118, v24
    v_mul_f32 v119, v119, v24
    v_cvt_pk_bf16_f32 v152, v112, v113
    v_cvt_pk_bf16_f32 v153, v114, v115
    v_cvt_pk_bf16_f32 v154, v116, v117
    v_cvt_pk_bf16_f32 v155, v118, v119
    buffer_store_dwordx4 v[152:155], v2, s[36:39], s45 offen offset:2048 sc0 sc1
    v_mul_f32 v120, v120, v24
    v_mul_f32 v121, v121, v24
    v_mul_f32 v122, v122, v24
    v_mul_f32 v123, v123, v24
    v_mul_f32 v124, v124, v24
    v_mul_f32 v125, v125, v24
    v_mul_f32 v126, v126, v24
    v_mul_f32 v127, v127, v24
    v_cvt_pk_bf16_f32 v156, v120, v121
    v_cvt_pk_bf16_f32 v157, v122, v123
    v_cvt_pk_bf16_f32 v158, v124, v125
    v_cvt_pk_bf16_f32 v159, v126, v127
    buffer_store_dwordx4 v[156:159], v2, s[36:39], s45 offen offset:3072 sc0 sc1
    s_endpgm
Lslow_6:
    v_mov_b32 v25, v24
    s_nop 1
    v_permlane32_swap_b32 v24, v25
    v_max3_f32 v24, v24, v25, s59
    v_max_f32 v25, 0, v24
    v_exp_f32 v30, -v25
    v_sub_f32 v128, v128, v24
    v_sub_f32 v129, v129, v24
    v_sub_f32 v130, v130, v24
    v_sub_f32 v131, v131, v24
    v_sub_f32 v132, v132, v24
    v_sub_f32 v133, v133, v24
    v_sub_f32 v134, v134, v24
    v_sub_f32 v135, v135, v24
    v_sub_f32 v136, v136, v24
    v_sub_f32 v137, v137, v24
    v_sub_f32 v138, v138, v24
    v_sub_f32 v139, v139, v24
    v_sub_f32 v140, v140, v24
    v_sub_f32 v141, v141, v24
    v_sub_f32 v142, v142, v24
    v_sub_f32 v143, v143, v24
    v_sub_f32 v144, v144, v24
    v_sub_f32 v145, v145, v24
    v_sub_f32 v146, v146, v24
    v_sub_f32 v147, v147, v24
    v_sub_f32 v148, v148, v24
    v_sub_f32 v149, v149, v24
    v_sub_f32 v150, v150, v24
    v_sub_f32 v151, v151, v24
    v_sub_f32 v152, v152, v24
    v_sub_f32 v153, v153, v24
    v_sub_f32 v154, v154, v24
    v_sub_f32 v155, v155, v24
    v_sub_f32 v156, v156, v24
    v_sub_f32 v157, v157, v24
    v_sub_f32 v158, v158, v24
    v_sub_f32 v159, v159, v24
    v_sub_f32 v208, v208, v24
    v_sub_f32 v209, v209, v24
    v_sub_f32 v210, v210, v24
    v_sub_f32 v211, v211, v24
    v_sub_f32 v212, v212, v24
    v_sub_f32 v213, v213, v24
    v_sub_f32 v214, v214, v24
    v_sub_f32 v215, v215, v24
    v_sub_f32 v216, v216, v24
    v_sub_f32 v217, v217, v24
    v_sub_f32 v218, v218, v24
    v_sub_f32 v219, v219, v24
    v_sub_f32 v220, v220, v24
    v_sub_f32 v221, v221, v24
    v_sub_f32 v222, v222, v24
    v_sub_f32 v223, v223, v24
    v_mul_f32 v23, v23, v30
    v_mul_f32 v64, v64, v30
    v_mul_f32 v65, v65, v30
    v_mul_f32 v66, v66, v30
    v_mul_f32 v67, v67, v30
    v_mul_f32 v68, v68, v30
    v_mul_f32 v69, v69, v30
    v_mul_f32 v70, v70, v30
    v_mul_f32 v71, v71, v30
    v_mul_f32 v72, v72, v30
    v_mul_f32 v73, v73, v30
    v_mul_f32 v74, v74, v30
    v_mul_f32 v75, v75, v30
    v_mul_f32 v76, v76, v30
    v_mul_f32 v77, v77, v30
    v_mul_f32 v78, v78, v30
    v_mul_f32 v79, v79, v30
    v_mul_f32 v80, v80, v30
    v_mul_f32 v81, v81, v30
    v_mul_f32 v82, v82, v30
    v_mul_f32 v83, v83, v30
    v_mul_f32 v84, v84, v30
    v_mul_f32 v85, v85, v30
    v_mul_f32 v86, v86, v30
    v_mul_f32 v87, v87, v30
    v_mul_f32 v88, v88, v30
    v_mul_f32 v89, v89, v30
    v_mul_f32 v90, v90, v30
    v_mul_f32 v91, v91, v30
    v_mul_f32 v92, v92, v30
    v_mul_f32 v93, v93, v30
    v_mul_f32 v94, v94, v30
    v_mul_f32 v95, v95, v30
    v_mul_f32 v96, v96, v30
    v_mul_f32 v97, v97, v30
    v_mul_f32 v98, v98, v30
    v_mul_f32 v99, v99, v30
    v_mul_f32 v100, v100, v30
    v_mul_f32 v101, v101, v30
    v_mul_f32 v102, v102, v30
    v_mul_f32 v103, v103, v30
    v_mul_f32 v104, v104, v30
    v_mul_f32 v105, v105, v30
    v_mul_f32 v106, v106, v30
    v_mul_f32 v107, v107, v30
    v_mul_f32 v108, v108, v30
    v_mul_f32 v109, v109, v30
    v_mul_f32 v110, v110, v30
    v_mul_f32 v111, v111, v30
    v_mul_f32 v112, v112, v30
    v_mul_f32 v113, v113, v30
    v_mul_f32 v114, v114, v30
    v_mul_f32 v115, v115, v30
    v_mul_f32 v116, v116, v30
    v_mul_f32 v117, v117, v30
    v_mul_f32 v118, v118, v30
    v_mul_f32 v119, v119, v30
    v_mul_f32 v120, v120, v30
    v_mul_f32 v121, v121, v30
    v_mul_f32 v122, v122, v30
    v_mul_f32 v123, v123, v30
    v_mul_f32 v124, v124, v30
    v_mul_f32 v125, v125, v30
    v_mul_f32 v126, v126, v30
    v_mul_f32 v127, v127, v30
    s_mov_b32 s55, 0x41000000
    s_mov_b32 s59, 0
    s_nop 1
    s_branch Lback_7
Lslow_12:
    v_mov_b32 v25, v24
    s_nop 1
    v_permlane32_swap_b32 v24, v25
    v_max3_f32 v24, v24, v25, s59
    v_max_f32 v25, 0, v24
    v_exp_f32 v30, -v25
    v_sub_f32 v160, v160, v24
    v_sub_f32 v161, v161, v24
    v_sub_f32 v162, v162, v24
    v_sub_f32 v163, v163, v24
    v_sub_f32 v164, v164, v24
    v_sub_f32 v165, v165, v24
    v_sub_f32 v166, v166, v24
    v_sub_f32 v167, v167, v24
    v_sub_f32 v168, v168, v24
    v_sub_f32 v169, v169, v24
    v_sub_f32 v170, v170, v24
    v_sub_f32 v171, v171, v24
    v_sub_f32 v172, v172, v24
    v_sub_f32 v173, v173, v24
    v_sub_f32 v174, v174, v24
    v_sub_f32 v175, v175, v24
    v_sub_f32 v176, v176, v24
    v_sub_f32 v177, v177, v24
    v_sub_f32 v178, v178, v24
    v_sub_f32 v179, v179, v24
    v_sub_f32 v180, v180, v24
    v_sub_f32 v181, v181, v24
    v_sub_f32 v182, v182, v24
    v_sub_f32 v183, v183, v24
    v_sub_f32 v184, v184, v24
    v_sub_f32 v185, v185, v24
    v_sub_f32 v186, v186, v24
    v_sub_f32 v187, v187, v24
    v_sub_f32 v188, v188, v24
    v_sub_f32 v189, v189, v24
    v_sub_f32 v190, v190, v24
    v_sub_f32 v191, v191, v24
    v_sub_f32 v208, v208, v24
    v_sub_f32 v209, v209, v24
    v_sub_f32 v210, v210, v24
    v_sub_f32 v211, v211, v24
    v_sub_f32 v212, v212, v24
    v_sub_f32 v213, v213, v24
    v_sub_f32 v214, v214, v24
    v_sub_f32 v215, v215, v24
    v_sub_f32 v216, v216, v24
    v_sub_f32 v217, v217, v24
    v_sub_f32 v218, v218, v24
    v_sub_f32 v219, v219, v24
    v_sub_f32 v220, v220, v24
    v_sub_f32 v221, v221, v24
    v_sub_f32 v222, v222, v24
    v_sub_f32 v223, v223, v24
    v_mul_f32 v23, v23, v30
    v_mul_f32 v64, v64, v30
    v_mul_f32 v65, v65, v30
    v_mul_f32 v66, v66, v30
    v_mul_f32 v67, v67, v30
    v_mul_f32 v68, v68, v30
    v_mul_f32 v69, v69, v30
    v_mul_f32 v70, v70, v30
    v_mul_f32 v71, v71, v30
    v_mul_f32 v72, v72, v30
    v_mul_f32 v73, v73, v30
    v_mul_f32 v74, v74, v30
    v_mul_f32 v75, v75, v30
    v_mul_f32 v76, v76, v30
    v_mul_f32 v77, v77, v30
    v_mul_f32 v78, v78, v30
    v_mul_f32 v79, v79, v30
    v_mul_f32 v80, v80, v30
    v_mul_f32 v81, v81, v30
    v_mul_f32 v82, v82, v30
    v_mul_f32 v83, v83, v30
    v_mul_f32 v84, v84, v30
    v_mul_f32 v85, v85, v30
    v_mul_f32 v86, v86, v30
    v_mul_f32 v87, v87, v30
    v_mul_f32 v88, v88, v30
    v_mul_f32 v89, v89, v30
    v_mul_f32 v90, v90, v30
    v_mul_f32 v91, v91, v30
    v_mul_f32 v92, v92, v30
    v_mul_f32 v93, v93, v30
    v_mul_f32 v94, v94, v30
    v_mul_f32 v95, v95, v30
    v_mul_f32 v96, v96, v30
    v_mul_f32 v97, v97, v30
    v_mul_f32 v98, v98, v30
    v_mul_f32 v99, v99, v30
    v_mul_f32 v100, v100, v30
    v_mul_f32 v101, v101, v30
    v_mul_f32 v102, v102, v30
    v_mul_f32 v103, v103, v30
    v_mul_f32 v104, v104, v30
    v_mul_f32 v105, v105, v30
    v_mul_f32 v106, v106, v30
    v_mul_f32 v107, v107, v30
    v_mul_f32 v108, v108, v30
    v_mul_f32 v109, v109, v30
    v_mul_f32 v110, v110, v30
    v_mul_f32 v111, v111, v30
    v_mul_f32 v112, v112, v30
    v_mul_f32 v113, v113, v30
    v_mul_f32 v114, v114, v30
    v_mul_f32 v115, v115, v30
    v_mul_f32 v116, v116, v30
    v_mul_f32 v117, v117, v30
    v_mul_f32 v118, v118, v30
    v_mul_f32 v119, v119, v30
    v_mul_f32 v120, v120, v30
    v_mul_f32 v121, v121, v30
    v_mul_f32 v122, v122, v30
    v_mul_f32 v123, v123, v30
    v_mul_f32 v124, v124, v30
    v_mul_f32 v125, v125, v30
    v_mul_f32 v126, v126, v30
    v_mul_f32 v127, v127, v30
    s_mov_b32 s55, 0x41000000
    s_mov_b32 s59, 0
    s_nop 1
    s_branch Lback_13
Lslow_18:
    v_mov_b32 v25, v24
    s_nop 1
    v_permlane32_swap_b32 v24, v25
    v_max3_f32 v24, v24, v25, s59
    v_max_f32 v25, 0, v24
    v_exp_f32 v30, -v25
    v_sub_f32 v128, v128, v24
    v_sub_f32 v129, v129, v24
    v_sub_f32 v130, v130, v24
    v_sub_f32 v131, v131, v24
    v_sub_f32 v132, v132, v24
    v_sub_f32 v133, v133, v24
    v_sub_f32 v134, v134, v24
    v_sub_f32 v135, v135, v24
    v_sub_f32 v136, v136, v24
    v_sub_f32 v137, v137, v24
    v_sub_f32 v138, v138, v24
    v_sub_f32 v139, v139, v24
    v_sub_f32 v140, v140, v24
    v_sub_f32 v141, v141, v24
    v_sub_f32 v142, v142, v24
    v_sub_f32 v143, v143, v24
    v_sub_f32 v144, v144, v24
    v_sub_f32 v145, v145, v24
    v_sub_f32 v146, v146, v24
    v_sub_f32 v147, v147, v24
    v_sub_f32 v148, v148, v24
    v_sub_f32 v149, v149, v24
    v_sub_f32 v150, v150, v24
    v_sub_f32 v151, v151, v24
    v_sub_f32 v152, v152, v24
    v_sub_f32 v153, v153, v24
    v_sub_f32 v154, v154, v24
    v_sub_f32 v155, v155, v24
    v_sub_f32 v156, v156, v24
    v_sub_f32 v157, v157, v24
    v_sub_f32 v158, v158, v24
    v_sub_f32 v159, v159, v24
    v_sub_f32 v208, v208, v24
    v_sub_f32 v209, v209, v24
    v_sub_f32 v210, v210, v24
    v_sub_f32 v211, v211, v24
    v_sub_f32 v212, v212, v24
    v_sub_f32 v213, v213, v24
    v_sub_f32 v214, v214, v24
    v_sub_f32 v215, v215, v24
    v_sub_f32 v216, v216, v24
    v_sub_f32 v217, v217, v24
    v_sub_f32 v218, v218, v24
    v_sub_f32 v219, v219, v24
    v_sub_f32 v220, v220, v24
    v_sub_f32 v221, v221, v24
    v_sub_f32 v222, v222, v24
    v_sub_f32 v223, v223, v24
    v_mul_f32 v23, v23, v30
    v_mul_f32 v64, v64, v30
    v_mul_f32 v65, v65, v30
    v_mul_f32 v66, v66, v30
    v_mul_f32 v67, v67, v30
    v_mul_f32 v68, v68, v30
    v_mul_f32 v69, v69, v30
    v_mul_f32 v70, v70, v30
    v_mul_f32 v71, v71, v30
    v_mul_f32 v72, v72, v30
    v_mul_f32 v73, v73, v30
    v_mul_f32 v74, v74, v30
    v_mul_f32 v75, v75, v30
    v_mul_f32 v76, v76, v30
    v_mul_f32 v77, v77, v30
    v_mul_f32 v78, v78, v30
    v_mul_f32 v79, v79, v30
    v_mul_f32 v80, v80, v30
    v_mul_f32 v81, v81, v30
    v_mul_f32 v82, v82, v30
    v_mul_f32 v83, v83, v30
    v_mul_f32 v84, v84, v30
    v_mul_f32 v85, v85, v30
    v_mul_f32 v86, v86, v30
    v_mul_f32 v87, v87, v30
    v_mul_f32 v88, v88, v30
    v_mul_f32 v89, v89, v30
    v_mul_f32 v90, v90, v30
    v_mul_f32 v91, v91, v30
    v_mul_f32 v92, v92, v30
    v_mul_f32 v93, v93, v30
    v_mul_f32 v94, v94, v30
    v_mul_f32 v95, v95, v30
    v_mul_f32 v96, v96, v30
    v_mul_f32 v97, v97, v30
    v_mul_f32 v98, v98, v30
    v_mul_f32 v99, v99, v30
    v_mul_f32 v100, v100, v30
    v_mul_f32 v101, v101, v30
    v_mul_f32 v102, v102, v30
    v_mul_f32 v103, v103, v30
    v_mul_f32 v104, v104, v30
    v_mul_f32 v105, v105, v30
    v_mul_f32 v106, v106, v30
    v_mul_f32 v107, v107, v30
    v_mul_f32 v108, v108, v30
    v_mul_f32 v109, v109, v30
    v_mul_f32 v110, v110, v30
    v_mul_f32 v111, v111, v30
    v_mul_f32 v112, v112, v30
    v_mul_f32 v113, v113, v30
    v_mul_f32 v114, v114, v30
    v_mul_f32 v115, v115, v30
    v_mul_f32 v116, v116, v30
    v_mul_f32 v117, v117, v30
    v_mul_f32 v118, v118, v30
    v_mul_f32 v119, v119, v30
    v_mul_f32 v120, v120, v30
    v_mul_f32 v121, v121, v30
    v_mul_f32 v122, v122, v30
    v_mul_f32 v123, v123, v30
    v_mul_f32 v124, v124, v30
    v_mul_f32 v125, v125, v30
    v_mul_f32 v126, v126, v30
    v_mul_f32 v127, v127, v30
    s_mov_b32 s55, 0x41000000
    s_mov_b32 s59, 0
    s_nop 1
    s_branch Lback_19
Lslow_22:
    v_mov_b32 v25, v24
    s_nop 1
    v_permlane32_swap_b32 v24, v25
    v_max3_f32 v24, v24, v25, s59
    v_max_f32 v25, 0, v24
    v_exp_f32 v30, -v25
    v_sub_f32 v160, v160, v24
    v_sub_f32 v161, v161, v24
    v_sub_f32 v162, v162, v24
    v_sub_f32 v163, v163, v24
    v_sub_f32 v164, v164, v24
    v_sub_f32 v165, v165, v24
    v_sub_f32 v166, v166, v24
    v_sub_f32 v167, v167, v24
    v_sub_f32 v168, v168, v24
    v_sub_f32 v169, v169, v24
    v_sub_f32 v170, v170, v24
    v_sub_f32 v171, v171, v24
    v_sub_f32 v172, v172, v24
    v_sub_f32 v173, v173, v24
    v_sub_f32 v174, v174, v24
    v_sub_f32 v175, v175, v24
    v_sub_f32 v176, v176, v24
    v_sub_f32 v177, v177, v24
    v_sub_f32 v178, v178, v24
    v_sub_f32 v179, v179, v24
    v_sub_f32 v180, v180, v24
    v_sub_f32 v181, v181, v24
    v_sub_f32 v182, v182, v24
    v_sub_f32 v183, v183, v24
    v_sub_f32 v184, v184, v24
    v_sub_f32 v185, v185, v24
    v_sub_f32 v186, v186, v24
    v_sub_f32 v187, v187, v24
    v_sub_f32 v188, v188, v24
    v_sub_f32 v189, v189, v24
    v_sub_f32 v190, v190, v24
    v_sub_f32 v191, v191, v24
    v_sub_f32 v208, v208, v24
    v_sub_f32 v209, v209, v24
    v_sub_f32 v210, v210, v24
    v_sub_f32 v211, v211, v24
    v_sub_f32 v212, v212, v24
    v_sub_f32 v213, v213, v24
    v_sub_f32 v214, v214, v24
    v_sub_f32 v215, v215, v24
    v_sub_f32 v216, v216, v24
    v_sub_f32 v217, v217, v24
    v_sub_f32 v218, v218, v24
    v_sub_f32 v219, v219, v24
    v_sub_f32 v220, v220, v24
    v_sub_f32 v221, v221, v24
    v_sub_f32 v222, v222, v24
    v_sub_f32 v223, v223, v24
    v_mul_f32 v23, v23, v30
    v_mul_f32 v64, v64, v30
    v_mul_f32 v65, v65, v30
    v_mul_f32 v66, v66, v30
    v_mul_f32 v67, v67, v30
    v_mul_f32 v68, v68, v30
    v_mul_f32 v69, v69, v30
    v_mul_f32 v70, v70, v30
    v_mul_f32 v71, v71, v30
    v_mul_f32 v72, v72, v30
    v_mul_f32 v73, v73, v30
    v_mul_f32 v74, v74, v30
    v_mul_f32 v75, v75, v30
    v_mul_f32 v76, v76, v30
    v_mul_f32 v77, v77, v30
    v_mul_f32 v78, v78, v30
    v_mul_f32 v79, v79, v30
    v_mul_f32 v80, v80, v30
    v_mul_f32 v81, v81, v30
    v_mul_f32 v82, v82, v30
    v_mul_f32 v83, v83, v30
    v_mul_f32 v84, v84, v30
    v_mul_f32 v85, v85, v30
    v_mul_f32 v86, v86, v30
    v_mul_f32 v87, v87, v30
    v_mul_f32 v88, v88, v30
    v_mul_f32 v89, v89, v30
    v_mul_f32 v90, v90, v30
    v_mul_f32 v91, v91, v30
    v_mul_f32 v92, v92, v30
    v_mul_f32 v93, v93, v30
    v_mul_f32 v94, v94, v30
    v_mul_f32 v95, v95, v30
    v_mul_f32 v96, v96, v30
    v_mul_f32 v97, v97, v30
    v_mul_f32 v98, v98, v30
    v_mul_f32 v99, v99, v30
    v_mul_f32 v100, v100, v30
    v_mul_f32 v101, v101, v30
    v_mul_f32 v102, v102, v30
    v_mul_f32 v103, v103, v30
    v_mul_f32 v104, v104, v30
    v_mul_f32 v105, v105, v30
    v_mul_f32 v106, v106, v30
    v_mul_f32 v107, v107, v30
    v_mul_f32 v108, v108, v30
    v_mul_f32 v109, v109, v30
    v_mul_f32 v110, v110, v30
    v_mul_f32 v111, v111, v30
    v_mul_f32 v112, v112, v30
    v_mul_f32 v113, v113, v30
    v_mul_f32 v114, v114, v30
    v_mul_f32 v115, v115, v30
    v_mul_f32 v116, v116, v30
    v_mul_f32 v117, v117, v30
    v_mul_f32 v118, v118, v30
    v_mul_f32 v119, v119, v30
    v_mul_f32 v120, v120, v30
    v_mul_f32 v121, v121, v30
    v_mul_f32 v122, v122, v30
    v_mul_f32 v123, v123, v30
    v_mul_f32 v124, v124, v30
    v_mul_f32 v125, v125, v30
    v_mul_f32 v126, v126, v30
    v_mul_f32 v127, v127, v30
    s_mov_b32 s55, 0x41000000
    s_mov_b32 s59, 0
    s_nop 1
    s_branch Lback_23
L1_lq0:
    s_waitcnt lgkmcnt(0)
    s_mov_b32 s20, s4
    s_and_b32 s21, s5, 0xffff
    s_mov_b32 s22, 983040
    s_mov_b32 s23, 0x00020000
    s_mov_b32 s24, s6
    s_and_b32 s25, s7, 0xffff
    s_mov_b32 s26, 33554432
    s_mov_b32 s27, 0x00020000
    s_mov_b32 s28, s8
    s_and_b32 s29, s9, 0xffff
    s_mov_b32 s30, 33554432
    s_mov_b32 s31, 0x00020000
    s_mov_b32 s32, s10
    s_and_b32 s33, s11, 0xffff
    s_mov_b32 s34, 5242880
    s_mov_b32 s35, 0x00020000
    s_lshl_b32 s60, s62, 19
    s_add_u32 s60, s60, s45
    s_lshl_b32 s61, s62, 7
    s_add_u32 s61, s61, s46
    s_add_u32 s62, s62, 2
    s_cmp_ge_u32 s62, 10
    s_cselect_b32 s63, 10, 0
    s_sub_u32 s62, s62, s63
    s_mov_b32 m0, 0
    s_add_u32 s48, s60, 0
    buffer_load_dwordx4 v10, s[32:35], s48 offen  lds
    s_mov_b32 m0, 1024
    s_add_u32 s48, s60, 32768
    buffer_load_dwordx4 v10, s[32:35], s48 offen  lds
    s_mov_b32 m0, 2048
    s_add_u32 s48, s60, 65536
    buffer_load_dwordx4 v10, s[32:35], s48 offen  lds
    s_mov_b32 m0, 3072
    s_add_u32 s48, s60, 98304
    buffer_load_dwordx4 v10, s[32:35], s48 offen  lds
    s_mov_b32 m0, 4096
    s_add_u32 s48, s60, 131072
    buffer_load_dwordx4 v10, s[32:35], s48 offen  lds
    s_mov_b32 m0, 5120
    s_add_u32 s48, s60, 163840
    buffer_load_dwordx4 v10, s[32:35], s48 offen  lds
    s_mov_b32 m0, 6144
    s_add_u32 s48, s60, 196608
    buffer_load_dwordx4 v10, s[32:35], s48 offen  lds
    s_mov_b32 m0, 7168
    s_add_u32 s48, s60, 229376
    buffer_load_dwordx4 v10, s[32:35], s48 offen  lds
    s_mov_b32 m0, 8192
    s_add_u32 s48, s60, 262144
    buffer_load_dwordx4 v10, s[32:35], s48 offen  lds
    s_mov_b32 m0, 9216
    s_add_u32 s48, s60, 294912
    buffer_load_dwordx4 v10, s[32:35], s48 offen  lds
    s_mov_b32 m0, 10240
    s_add_u32 s48, s60, 327680
    buffer_load_dwordx4 v10, s[32:35], s48 offen  lds
    s_mov_b32 m0, 11264
    s_add_u32 s48, s60, 360448
    buffer_load_dwordx4 v10, s[32:35], s48 offen  lds
    s_mov_b32 m0, 12288
    s_add_u32 s48, s60, 393216
    buffer_load_dwordx4 v10, s[32:35], s48 offen  lds
    s_mov_b32 m0, 13312
    s_add_u32 s48, s60, 425984
    buffer_load_dwordx4 v10, s[32:35], s48 offen  lds
    s_mov_b32 m0, 14336
    s_add_u32 s48, s60, 458752
    buffer_load_dwordx4 v10, s[32:35], s48 offen  lds
    s_mov_b32 m0, 15360
    s_add_u32 s48, s60, 491520
    buffer_load_dwordx4 v10, s[32:35], s48 offen  lds
    s_mov_b32 m0, 16384
    s_add_u32 s48, s61, 0
    buffer_load_dwordx4 v16, s[20:23], s48 offen  lds
    s_mov_b32 m0, 17408
    s_add_u32 s48, s61, 10240
    buffer_load_dwordx4 v17, s[20:23], s48 offen  lds
    s_mov_b32 m0, 18432
    s_add_u32 s48, s61, 20480
    buffer_load_dwordx4 v16, s[20:23], s48 offen  lds
    s_mov_b32 m0, 19456
    s_add_u32 s48, s61, 30720
    buffer_load_dwordx4 v17, s[20:23], s48 offen  lds
    s_mov_b32 m0, 20480
    s_add_u32 s48, s61, 40960
    buffer_load_dwordx4 v16, s[20:23], s48 offen  lds
    s_mov_b32 m0, 21504
    s_add_u32 s48, s61, 51200
    buffer_load_dwordx4 v17, s[20:23], s48 offen  lds
    s_mov_b32 m0, 22528
    s_add_u32 s48, s61, 61440
    buffer_load_dwordx4 v16, s[20:23], s48 offen  lds
    s_mov_b32 m0, 23552
    s_add_u32 s48, s61, 71680
    buffer_load_dwordx4 v17, s[20:23], s48 offen  lds
    s_mov_b32 m0, 24576
    s_add_u32 s48, s61, 81920
    buffer_load_dwordx4 v16, s[20:23], s48 offen  lds
    s_mov_b32 m0, 25600
    s_add_u32 s48, s61, 92160
    buffer_load_dwordx4 v17, s[20:23], s48 offen  lds
    s_mov_b32 m0, 26624
    s_add_u32 s48, s61, 102400
    buffer_load_dwordx4 v16, s[20:23], s48 offen  lds
    s_mov_b32 m0, 27648
    s_add_u32 s48, s61, 112640
    buffer_load_dwordx4 v17, s[20:23], s48 offen  lds
    s_lshl_b32 s60, s62, 19
    s_add_u32 s60, s60, s45
    s_lshl_b32 s61, s62, 7
    s_add_u32 s61, s61, s46
    s_add_u32 s62, s62, 2
    s_cmp_ge_u32 s62, 10
    s_cselect_b32 s63, 10, 0
    s_sub_u32 s62, s62, s63
    s_mov_b32 m0, 57344
    s_add_u32 s48, s60, 0
    buffer_load_dwordx4 v10, s[32:35], s48 offen  lds
    s_mov_b32 m0, 58368
    s_add_u32 s48, s60, 32768
    buffer_load_dwordx4 v10, s[32:35], s48 offen  lds
    s_mov_b32 m0, 59392
    s_add_u32 s48, s60, 65536
    buffer_load_dwordx4 v10, s[32:35], s48 offen  lds
    s_mov_b32 m0, 60416
    s_add_u32 s48, s60, 98304
    buffer_load_dwordx4 v10, s[32:35], s48 offen  lds
    s_mov_b32 m0, 61440
    s_add_u32 s48, s60, 131072
    buffer_load_dwordx4 v10, s[32:35], s48 offen  lds
    s_mov_b32 m0, 62464
    s_add_u32 s48, s60, 163840
    buffer_load_dwordx4 v10, s[32:35], s48 offen  lds
    s_mov_b32 m0, 63488
    s_add_u32 s48, s60, 196608
    buffer_load_dwordx4 v10, s[32:35], s48 offen  lds
    s_mov_b32 m0, 64512
    s_add_u32 s48, s60, 229376
    buffer_load_dwordx4 v10, s[32:35], s48 offen  lds
    s_mov_b32 m0, 65536
    s_add_u32 s48, s60, 262144
    buffer_load_dwordx4 v10, s[32:35], s48 offen  lds
    s_mov_b32 m0, 66560
    s_add_u32 s48, s60, 294912
    buffer_load_dwordx4 v10, s[32:35], s48 offen  lds
    s_mov_b32 m0, 67584
    s_add_u32 s48, s60, 327680
    buffer_load_dwordx4 v10, s[32:35], s48 offen  lds
    s_mov_b32 m0, 68608
    s_add_u32 s48, s60, 360448
    buffer_load_dwordx4 v10, s[32:35], s48 offen  lds
    s_mov_b32 m0, 69632
    s_add_u32 s48, s60, 393216
    buffer_load_dwordx4 v10, s[32:35], s48 offen  lds
    s_mov_b32 m0, 70656
    s_add_u32 s48, s60, 425984
    buffer_load_dwordx4 v10, s[32:35], s48 offen  lds
    s_mov_b32 m0, 71680
    s_add_u32 s48, s60, 458752
    buffer_load_dwordx4 v10, s[32:35], s48 offen  lds
    s_mov_b32 m0, 72704
    s_add_u32 s48, s60, 491520
    buffer_load_dwordx4 v10, s[32:35], s48 offen  lds
    s_mov_b32 m0, 73728
    s_add_u32 s48, s61, 0
    buffer_load_dwordx4 v16, s[20:23], s48 offen  lds
    s_mov_b32 m0, 74752
    s_add_u32 s48, s61, 10240
    buffer_load_dwordx4 v17, s[20:23], s48 offen  lds
    s_mov_b32 m0, 75776
    s_add_u32 s48, s61, 20480
    buffer_load_dwordx4 v16, s[20:23], s48 offen  lds
    s_mov_b32 m0, 76800
    s_add_u32 s48, s61, 30720
    buffer_load_dwordx4 v17, s[20:23], s48 offen  lds
    s_mov_b32 m0, 77824
    s_add_u32 s48, s61, 40960
    buffer_load_dwordx4 v16, s[20:23], s48 offen  lds
    s_mov_b32 m0, 78848
    s_add_u32 s48, s61, 51200
    buffer_load_dwordx4 v17, s[20:23], s48 offen  lds
    s_mov_b32 m0, 79872
    s_add_u32 s48, s61, 61440
    buffer_load_dwordx4 v16, s[20:23], s48 offen  lds
    s_mov_b32 m0, 80896
    s_add_u32 s48, s61, 71680
    buffer_load_dwordx4 v17, s[20:23], s48 offen  lds
    s_mov_b32 m0, 81920
    s_add_u32 s48, s61, 81920
    buffer_load_dwordx4 v16, s[20:23], s48 offen  lds
    s_mov_b32 m0, 82944
    s_add_u32 s48, s61, 92160
    buffer_load_dwordx4 v17, s[20:23], s48 offen  lds
    s_mov_b32 m0, 83968
    s_add_u32 s48, s61, 102400
    buffer_load_dwordx4 v16, s[20:23], s48 offen  lds
    s_mov_b32 m0, 84992
    s_add_u32 s48, s61, 112640
    buffer_load_dwordx4 v17, s[20:23], s48 offen  lds
    s_barrier
    s_waitcnt vmcnt(28)
    s_mov_b64 exec, 1
    ds_write_b32 v6, v7 offset:0
    s_mov_b64 exec, -1
    s_lshl_b32 s60, s62, 19
    s_add_u32 s60, s60, s45
    s_lshl_b32 s61, s62, 7
    s_add_u32 s61, s61, s46
    s_add_u32 s62, s62, 2
    s_cmp_ge_u32 s62, 10
    s_cselect_b32 s63, 10, 0
    s_sub_u32 s62, s62, s63
    s_mov_b32 m0, 114688
    s_add_u32 s48, s60, 0
    buffer_load_dwordx4 v10, s[32:35], s48 offen  lds
    s_mov_b32 m0, 115712
    s_add_u32 s48, s60, 32768
    buffer_load_dwordx4 v10, s[32:35], s48 offen  lds
    s_mov_b32 m0, 116736
    s_add_u32 s48, s60, 65536
    buffer_load_dwordx4 v10, s[32:35], s48 offen  lds
    s_mov_b32 m0, 117760
    s_add_u32 s48, s60, 98304
    buffer_load_dwordx4 v10, s[32:35], s48 offen  lds
    s_mov_b32 m0, 118784
    s_add_u32 s48, s60, 131072
    buffer_load_dwordx4 v10, s[32:35], s48 offen  lds
    s_mov_b32 m0, 119808
    s_add_u32 s48, s60, 163840
    buffer_load_dwordx4 v10, s[32:35], s48 offen  lds
    s_mov_b32 m0, 120832
    s_add_u32 s48, s60, 196608
    buffer_load_dwordx4 v10, s[32:35], s48 offen  lds
    s_mov_b32 m0, 121856
    s_add_u32 s48, s60, 229376
    buffer_load_dwordx4 v10, s[32:35], s48 offen  lds
    s_mov_b32 m0, 122880
    s_add_u32 s48, s60, 262144
    buffer_load_dwordx4 v10, s[32:35], s48 offen  lds
    s_mov_b32 m0, 123904
    s_add_u32 s48, s60, 294912
    buffer_load_dwordx4 v10, s[32:35], s48 offen  lds
    s_mov_b32 m0, 124928
    s_add_u32 s48, s60, 327680
    buffer_load_dwordx4 v10, s[32:35], s48 offen  lds
    s_mov_b32 m0, 125952
    s_add_u32 s48, s60, 360448
    buffer_load_dwordx4 v10, s[32:35], s48 offen  lds
    s_mov_b32 m0, 126976
    s_add_u32 s48, s60, 393216
    buffer_load_dwordx4 v10, s[32:35], s48 offen  lds
    s_mov_b32 m0, 128000
    s_add_u32 s48, s60, 425984
    buffer_load_dwordx4 v10, s[32:35], s48 offen  lds
    s_mov_b32 m0, 129024
    s_add_u32 s48, s60, 458752
    buffer_load_dwordx4 v10, s[32:35], s48 offen  lds
    s_mov_b32 m0, 130048
    s_add_u32 s48, s60, 491520
    buffer_load_dwordx4 v10, s[32:35], s48 offen  lds
    s_mov_b32 m0, 131072
    s_add_u32 s48, s61, 0
    buffer_load_dwordx4 v16, s[20:23], s48 offen  lds
    s_mov_b32 m0, 132096
    s_add_u32 s48, s61, 10240
    buffer_load_dwordx4 v17, s[20:23], s48 offen  lds
    s_mov_b32 m0, 133120
    s_add_u32 s48, s61, 20480
    buffer_load_dwordx4 v16, s[20:23], s48 offen  lds
    s_mov_b32 m0, 134144
    s_add_u32 s48, s61, 30720
    buffer_load_dwordx4 v17, s[20:23], s48 offen  lds
    s_mov_b32 m0, 135168
    s_add_u32 s48, s61, 40960
    buffer_load_dwordx4 v16, s[20:23], s48 offen  lds
    s_mov_b32 m0, 136192
    s_add_u32 s48, s61, 51200
    buffer_load_dwordx4 v17, s[20:23], s48 offen  lds
    s_mov_b32 m0, 137216
    s_add_u32 s48, s61, 61440
    buffer_load_dwordx4 v16, s[20:23], s48 offen  lds
    s_mov_b32 m0, 138240
    s_add_u32 s48, s61, 71680
    buffer_load_dwordx4 v17, s[20:23], s48 offen  lds
    s_mov_b32 m0, 139264
    s_add_u32 s48, s61, 81920
    buffer_load_dwordx4 v16, s[20:23], s48 offen  lds
    s_mov_b32 m0, 140288
    s_add_u32 s48, s61, 92160
    buffer_load_dwordx4 v17, s[20:23], s48 offen  lds
    s_mov_b32 m0, 141312
    s_add_u32 s48, s61, 102400
    buffer_load_dwordx4 v16, s[20:23], s48 offen  lds
    s_mov_b32 m0, 142336
    s_add_u32 s48, s61, 112640
    buffer_load_dwordx4 v17, s[20:23], s48 offen  lds
    s_waitcnt vmcnt(28)
    s_mov_b64 exec, 1
    ds_write_b32 v6, v7 offset:8
    s_mov_b64 exec, -1
    ds_read_b32 v20, v6 offset:132
    s_waitcnt lgkmcnt(0)
    v_readfirstlane_b32 s57, v20
    s_cmp_ge_u32 s57, 3
    s_cbranch_scc0 Lslow_26
    s_branch Lgo_25
Lslow_26:
    s_waitcnt vmcnt(0)
    s_mov_b64 exec, 1
    ds_write_b32 v6, v7 offset:16
    s_mov_b64 exec, -1
Lp_27:
    ds_read_b32 v5, v6 offset:132
    s_waitcnt lgkmcnt(0)
    v_readfirstlane_b32 s57, v5
    s_cmp_ge_u32 s57, 3
    s_cbranch_scc0 Lp_27
Lgo_25:
    s_lshl_b32 s60, s62, 19
    s_add_u32 s60, s60, s45
    s_lshl_b32 s61, s62, 7
    s_add_u32 s61, s61, s46
    s_add_u32 s62, s62, 2
    s_cmp_ge_u32 s62, 10
    s_cselect_b32 s63, 10, 0
    s_sub_u32 s62, s62, s63
    s_mov_b32 m0, 28672
    s_add_u32 s48, s60, 0
    buffer_load_dwordx4 v10, s[32:35], s48 offen  lds
    s_mov_b32 m0, 29696
    s_add_u32 s48, s60, 32768
    buffer_load_dwordx4 v10, s[32:35], s48 offen  lds
    s_mov_b32 m0, 30720
    s_add_u32 s48, s60, 65536
    buffer_load_dwordx4 v10, s[32:35], s48 offen  lds
    s_mov_b32 m0, 31744
    s_add_u32 s48, s60, 98304
    buffer_load_dwordx4 v10, s[32:35], s48 offen  lds
    s_mov_b32 m0, 32768
    s_add_u32 s48, s60, 131072
    buffer_load_dwordx4 v10, s[32:35], s48 offen  lds
    s_mov_b32 m0, 33792
    s_add_u32 s48, s60, 163840
    buffer_load_dwordx4 v10, s[32:35], s48 offen  lds
    s_mov_b32 m0, 34816
    s_add_u32 s48, s60, 196608
    buffer_load_dwordx4 v10, s[32:35], s48 offen  lds
    s_mov_b32 m0, 35840
    s_add_u32 s48, s60, 229376
    buffer_load_dwordx4 v10, s[32:35], s48 offen  lds
    s_mov_b32 m0, 36864
    s_add_u32 s48, s60, 262144
    buffer_load_dwordx4 v10, s[32:35], s48 offen  lds
    s_mov_b32 m0, 37888
    s_add_u32 s48, s60, 294912
    buffer_load_dwordx4 v10, s[32:35], s48 offen  lds
    s_mov_b32 m0, 38912
    s_add_u32 s48, s60, 327680
    buffer_load_dwordx4 v10, s[32:35], s48 offen  lds
    s_mov_b32 m0, 39936
    s_add_u32 s48, s60, 360448
    buffer_load_dwordx4 v10, s[32:35], s48 offen  lds
    s_mov_b32 m0, 40960
    s_add_u32 s48, s60, 393216
    buffer_load_dwordx4 v10, s[32:35], s48 offen  lds
    s_mov_b32 m0, 41984
    s_add_u32 s48, s60, 425984
    buffer_load_dwordx4 v10, s[32:35], s48 offen  lds
    s_mov_b32 m0, 43008
    s_add_u32 s48, s60, 458752
    buffer_load_dwordx4 v10, s[32:35], s48 offen  lds
    s_mov_b32 m0, 44032
    s_add_u32 s48, s60, 491520
    buffer_load_dwordx4 v10, s[32:35], s48 offen  lds
    s_mov_b32 m0, 45056
    s_add_u32 s48, s61, 0
    buffer_load_dwordx4 v16, s[20:23], s48 offen  lds
    s_mov_b32 m0, 46080
    s_add_u32 s48, s61, 10240
    buffer_load_dwordx4 v17, s[20:23], s48 offen  lds
    s_mov_b32 m0, 47104
    s_add_u32 s48, s61, 20480
    buffer_load_dwordx4 v16, s[20:23], s48 offen  lds
    s_mov_b32 m0, 48128
    s_add_u32 s48, s61, 30720
    buffer_load_dwordx4 v17, s[20:23], s48 offen  lds
    s_mov_b32 m0, 49152
    s_add_u32 s48, s61, 40960
    buffer_load_dwordx4 v16, s[20:23], s48 offen  lds
    s_mov_b32 m0, 50176
    s_add_u32 s48, s61, 51200
    buffer_load_dwordx4 v17, s[20:23], s48 offen  lds
    s_mov_b32 m0, 51200
    s_add_u32 s48, s61, 61440
    buffer_load_dwordx4 v16, s[20:23], s48 offen  lds
    s_mov_b32 m0, 52224
    s_add_u32 s48, s61, 71680
    buffer_load_dwordx4 v17, s[20:23], s48 offen  lds
    s_mov_b32 m0, 53248
    s_add_u32 s48, s61, 81920
    buffer_load_dwordx4 v16, s[20:23], s48 offen  lds
    s_mov_b32 m0, 54272
    s_add_u32 s48, s61, 92160
    buffer_load_dwordx4 v17, s[20:23], s48 offen  lds
    s_mov_b32 m0, 55296
    s_add_u32 s48, s61, 102400
    buffer_load_dwordx4 v16, s[20:23], s48 offen  lds
    s_mov_b32 m0, 56320
    s_add_u32 s48, s61, 112640
    buffer_load_dwordx4 v17, s[20:23], s48 offen  lds
    s_waitcnt vmcnt(28)
    s_mov_b64 exec, 1
    ds_write_b32 v6, v7 offset:16
    s_mov_b64 exec, -1
    ds_read_b32 v20, v6 offset:140
    s_waitcnt lgkmcnt(0)
    v_readfirstlane_b32 s57, v20
    s_cmp_ge_u32 s57, 3
    s_cbranch_scc0 Lslow_29
    s_branch Lgo_28
Lslow_29:
    s_waitcnt vmcnt(0)
    s_mov_b64 exec, 1
    ds_write_b32 v6, v7 offset:24
    s_mov_b64 exec, -1
Lp_30:
    ds_read_b32 v5, v6 offset:140
    s_waitcnt lgkmcnt(0)
    v_readfirstlane_b32 s57, v5
    s_cmp_ge_u32 s57, 3
    s_cbranch_scc0 Lp_30
Lgo_28:
    s_lshl_b32 s60, s62, 19
    s_add_u32 s60, s60, s45
    s_lshl_b32 s61, s62, 7
    s_add_u32 s61, s61, s46
    s_add_u32 s62, s62, 2
    s_cmp_ge_u32 s62, 10
    s_cselect_b32 s63, 10, 0
    s_sub_u32 s62, s62, s63
    s_mov_b32 m0, 86016
    s_add_u32 s48, s60, 0
    buffer_load_dwordx4 v10, s[32:35], s48 offen  lds
    s_mov_b32 m0, 87040
    s_add_u32 s48, s60, 32768
    buffer_load_dwordx4 v10, s[32:35], s48 offen  lds
    s_mov_b32 m0, 88064
    s_add_u32 s48, s60, 65536
    buffer_load_dwordx4 v10, s[32:35], s48 offen  lds
    s_mov_b32 m0, 89088
    s_add_u32 s48, s60, 98304
    buffer_load_dwordx4 v10, s[32:35], s48 offen  lds
    s_mov_b32 m0, 90112
    s_add_u32 s48, s60, 131072
    buffer_load_dwordx4 v10, s[32:35], s48 offen  lds
    s_mov_b32 m0, 91136
    s_add_u32 s48, s60, 163840
    buffer_load_dwordx4 v10, s[32:35], s48 offen  lds
    s_mov_b32 m0, 92160
    s_add_u32 s48, s60, 196608
    buffer_load_dwordx4 v10, s[32:35], s48 offen  lds
    s_mov_b32 m0, 93184
    s_add_u32 s48, s60, 229376
    buffer_load_dwordx4 v10, s[32:35], s48 offen  lds
    s_mov_b32 m0, 94208
    s_add_u32 s48, s60, 262144
    buffer_load_dwordx4 v10, s[32:35], s48 offen  lds
    s_mov_b32 m0, 95232
    s_add_u32 s48, s60, 294912
    buffer_load_dwordx4 v10, s[32:35], s48 offen  lds
    s_mov_b32 m0, 96256
    s_add_u32 s48, s60, 327680
    buffer_load_dwordx4 v10, s[32:35], s48 offen  lds
    s_mov_b32 m0, 97280
    s_add_u32 s48, s60, 360448
    buffer_load_dwordx4 v10, s[32:35], s48 offen  lds
    s_mov_b32 m0, 98304
    s_add_u32 s48, s60, 393216
    buffer_load_dwordx4 v10, s[32:35], s48 offen  lds
    s_mov_b32 m0, 99328
    s_add_u32 s48, s60, 425984
    buffer_load_dwordx4 v10, s[32:35], s48 offen  lds
    s_mov_b32 m0, 100352
    s_add_u32 s48, s60, 458752
    buffer_load_dwordx4 v10, s[32:35], s48 offen  lds
    s_mov_b32 m0, 101376
    s_add_u32 s48, s60, 491520
    buffer_load_dwordx4 v10, s[32:35], s48 offen  lds
    s_mov_b32 m0, 102400
    s_add_u32 s48, s61, 0
    buffer_load_dwordx4 v16, s[20:23], s48 offen  lds
    s_mov_b32 m0, 103424
    s_add_u32 s48, s61, 10240
    buffer_load_dwordx4 v17, s[20:23], s48 offen  lds
    s_mov_b32 m0, 104448
    s_add_u32 s48, s61, 20480
    buffer_load_dwordx4 v16, s[20:23], s48 offen  lds
    s_mov_b32 m0, 105472
    s_add_u32 s48, s61, 30720
    buffer_load_dwordx4 v17, s[20:23], s48 offen  lds
    s_mov_b32 m0, 106496
    s_add_u32 s48, s61, 40960
    buffer_load_dwordx4 v16, s[20:23], s48 offen  lds
    s_mov_b32 m0, 107520
    s_add_u32 s48, s61, 51200
    buffer_load_dwordx4 v17, s[20:23], s48 offen  lds
    s_mov_b32 m0, 108544
    s_add_u32 s48, s61, 61440
    buffer_load_dwordx4 v16, s[20:23], s48 offen  lds
    s_mov_b32 m0, 109568
    s_add_u32 s48, s61, 71680
    buffer_load_dwordx4 v17, s[20:23], s48 offen  lds
    s_mov_b32 m0, 110592
    s_add_u32 s48, s61, 81920
    buffer_load_dwordx4 v16, s[20:23], s48 offen  lds
    s_mov_b32 m0, 111616
    s_add_u32 s48, s61, 92160
    buffer_load_dwordx4 v17, s[20:23], s48 offen  lds
    s_mov_b32 m0, 112640
    s_add_u32 s48, s61, 102400
    buffer_load_dwordx4 v16, s[20:23], s48 offen  lds
    s_mov_b32 m0, 113664
    s_add_u32 s48, s61, 112640
    buffer_load_dwordx4 v17, s[20:23], s48 offen  lds
    s_waitcnt vmcnt(28)
    s_mov_b64 exec, 1
    ds_write_b32 v6, v7 offset:24
    s_mov_b64 exec, -1
    s_waitcnt vmcnt(0)
    s_mov_b64 exec, 1
    ds_write_b32 v6, v7 offset:32
    s_mov_b64 exec, -1
Lp_31:
    ds_read_b32 v5, v6 offset:256
    s_waitcnt lgkmcnt(0)
    v_readfirstlane_b32 s57, v5
    s_cmp_ge_u32 s57, 10
    s_cbranch_scc1 Lq_32
    s_sleep 2
    s_branch Lp_31
Lq_32:
    s_add_u32 s48, s47, 65536
    buffer_load_dwordx4 v[64:67], v11, s[28:31], s48 offen offset:0 nt
    buffer_load_dwordx4 v[68:71], v11, s[28:31], s48 offen offset:1024 nt
    buffer_load_dwordx4 v[72:75], v11, s[28:31], s48 offen offset:2048 nt
    buffer_load_dwordx4 v[76:79], v11, s[28:31], s48 offen offset:3072 nt
    s_add_u32 s48, s47, 69632
    buffer_load_dwordx4 v[80:83], v11, s[28:31], s48 offen offset:0 nt
    buffer_load_dwordx4 v[84:87], v11, s[28:31], s48 offen offset:1024 nt
    buffer_load_dwordx4 v[88:91], v11, s[28:31], s48 offen offset:2048 nt
    buffer_load_dwordx4 v[92:95], v11, s[28:31], s48 offen offset:3072 nt
    s_add_u32 s48, s47, 73728
    buffer_load_dwordx4 v[96:99], v11, s[28:31], s48 offen offset:0 nt
    buffer_load_dwordx4 v[100:103], v11, s[28:31], s48 offen offset:1024 nt
    buffer_load_dwordx4 v[104:107], v11, s[28:31], s48 offen offset:2048 nt
    buffer_load_dwordx4 v[108:111], v11, s[28:31], s48 offen offset:3072 nt
    s_add_u32 s48, s47, 77824
    buffer_load_dwordx4 v[112:115], v11, s[28:31], s48 offen offset:0 nt
    buffer_load_dwordx4 v[116:119], v11, s[28:31], s48 offen offset:1024 nt
    buffer_load_dwordx4 v[120:123], v11, s[28:31], s48 offen offset:2048 nt
    buffer_load_dwordx4 v[124:127], v11, s[28:31], s48 offen offset:3072 nt
Lp_33:
    ds_read_b32 v5, v6 offset:256
    s_waitcnt lgkmcnt(0)
    v_readfirstlane_b32 s57, v5
    s_cmp_ge_u32 s57, 12
    s_cbranch_scc1 Lq_34
    s_sleep 2
    s_branch Lp_33
Lq_34:
    s_add_u32 s48, s47, 81920
    buffer_load_dwordx4 v[128:131], v11, s[28:31], s48 offen offset:0 nt
    buffer_load_dwordx4 v[132:135], v11, s[28:31], s48 offen offset:1024 nt
    buffer_load_dwordx4 v[136:139], v11, s[28:31], s48 offen offset:2048 nt
    buffer_load_dwordx4 v[140:143], v11, s[28:31], s48 offen offset:3072 nt
    s_add_u32 s48, s47, 86016
    buffer_load_dwordx4 v[144:147], v11, s[28:31], s48 offen offset:0 nt
    buffer_load_dwordx4 v[148:151], v11, s[28:31], s48 offen offset:1024 nt
    buffer_load_dwordx4 v[152:155], v11, s[28:31], s48 offen offset:2048 nt
    buffer_load_dwordx4 v[156:159], v11, s[28:31], s48 offen offset:3072 nt
    s_add_u32 s48, s47, 90112
    buffer_load_dwordx4 v[160:163], v11, s[28:31], s48 offen offset:0 nt
    buffer_load_dwordx4 v[164:167], v11, s[28:31], s48 offen offset:1024 nt
    buffer_load_dwordx4 v[168:171], v11, s[28:31], s48 offen offset:2048 nt
    buffer_load_dwordx4 v[172:175], v11, s[28:31], s48 offen offset:3072 nt
    s_add_u32 s48, s47, 94208
    buffer_load_dwordx4 v[176:179], v11, s[28:31], s48 offen offset:0 nt
    buffer_load_dwordx4 v[180:183], v11, s[28:31], s48 offen offset:1024 nt
    buffer_load_dwordx4 v[184:187], v11, s[28:31], s48 offen offset:2048 nt
    buffer_load_dwordx4 v[188:191], v11, s[28:31], s48 offen offset:3072 nt
    s_waitcnt vmcnt(16)
    s_mov_b64 exec, 1
    ds_add_u32 v6, v7 offset:256
    s_mov_b64 exec, -1
Lp_35:
    ds_read_b32 v5, v6 offset:256
    s_waitcnt lgkmcnt(0)
    v_readfirstlane_b32 s57, v5
    s_cmp_ge_u32 s57, 14
    s_cbranch_scc1 Lq_36
    s_sleep 2
    s_branch Lp_35
Lq_36:
    s_add_u32 s48, s47, 98304
    buffer_load_dwordx4 v[192:195], v11, s[28:31], s48 offen offset:0 nt
    buffer_load_dwordx4 v[196:199], v11, s[28:31], s48 offen offset:1024 nt
    buffer_load_dwordx4 v[200:203], v11, s[28:31], s48 offen offset:2048 nt
    buffer_load_dwordx4 v[204:207], v11, s[28:31], s48 offen offset:3072 nt
    s_add_u32 s48, s47, 102400
    buffer_load_dwordx4 v[208:211], v11, s[28:31], s48 offen offset:0 nt
    buffer_load_dwordx4 v[212:215], v11, s[28:31], s48 offen offset:1024 nt
    buffer_load_dwordx4 v[216:219], v11, s[28:31], s48 offen offset:2048 nt
    buffer_load_dwordx4 v[220:223], v11, s[28:31], s48 offen offset:3072 nt
    s_add_u32 s48, s47, 106496
    buffer_load_dwordx4 v[224:227], v11, s[28:31], s48 offen offset:0 nt
    buffer_load_dwordx4 v[228:231], v11, s[28:31], s48 offen offset:1024 nt
    buffer_load_dwordx4 v[232:235], v11, s[28:31], s48 offen offset:2048 nt
    buffer_load_dwordx4 v[236:239], v11, s[28:31], s48 offen offset:3072 nt
    s_add_u32 s48, s47, 110592
    buffer_load_dwordx4 v[240:243], v11, s[28:31], s48 offen offset:0 nt
    buffer_load_dwordx4 v[244:247], v11, s[28:31], s48 offen offset:1024 nt
    buffer_load_dwordx4 v[248:251], v11, s[28:31], s48 offen offset:2048 nt
    buffer_load_dwordx4 v[252:255], v11, s[28:31], s48 offen offset:3072 nt
Lp_37:
    ds_read_b32 v5, v6 offset:196
    s_waitcnt lgkmcnt(0)
    v_readfirstlane_b32 s57, v5
    s_cmp_ge_u32 s57, 3
    s_cbranch_scc1 Lq_38
    s_sleep 1
    s_branch Lp_37
Lq_38:
    v_add_u32 v19, 0, v18
    ds_write_b128 v19, v[64:67] offset:0
    ds_write_b128 v19, v[68:71] offset:1024
    ds_write_b128 v19, v[72:75] offset:2048
    ds_write_b128 v19, v[76:79] offset:3072
    ds_write_b128 v19, v[80:83] offset:4096
    ds_write_b128 v19, v[84:87] offset:5120
    ds_write_b128 v19, v[88:91] offset:6144
    ds_write_b128 v19, v[92:95] offset:7168
    ds_write_b128 v19, v[96:99] offset:8192
    ds_write_b128 v19, v[100:103] offset:9216
    ds_write_b128 v19, v[104:107] offset:10240
    ds_write_b128 v19, v[108:111] offset:11264
    ds_write_b128 v19, v[112:115] offset:12288
    ds_write_b128 v19, v[116:119] offset:13312
    ds_write_b128 v19, v[120:123] offset:14336
    ds_write_b128 v19, v[124:127] offset:15360
    s_waitcnt lgkmcnt(0)
    s_mov_b64 exec, 1
    ds_write_b32 v6, v7 offset:112
    s_mov_b64 exec, -1
Lp_39:
    ds_read_b32 v5, v6 offset:200
    s_waitcnt lgkmcnt(0)
    v_readfirstlane_b32 s57, v5
    s_cmp_ge_u32 s57, 3
    s_cbranch_scc1 Lq_40
    s_sleep 1
    s_branch Lp_39
Lq_40:
    v_add_u32 v19, 32768, v18
    s_waitcnt vmcnt(28)
    ds_write_b128 v19, v[128:131] offset:0
    ds_write_b128 v19, v[132:135] offset:1024
    ds_write_b128 v19, v[136:139] offset:2048
    ds_write_b128 v19, v[140:143] offset:3072
    s_waitcnt vmcnt(24)
    ds_write_b128 v19, v[144:147] offset:4096
    ds_write_b128 v19, v[148:151] offset:5120
    ds_write_b128 v19, v[152:155] offset:6144
    ds_write_b128 v19, v[156:159] offset:7168
    s_waitcnt vmcnt(20)
    ds_write_b128 v19, v[160:163] offset:8192
    ds_write_b128 v19, v[164:167] offset:9216
    ds_write_b128 v19, v[168:171] offset:10240
    ds_write_b128 v19, v[172:175] offset:11264
    s_waitcnt vmcnt(16)
    ds_write_b128 v19, v[176:179] offset:12288
    ds_write_b128 v19, v[180:183] offset:13312
    ds_write_b128 v19, v[184:187] offset:14336
    ds_write_b128 v19, v[188:191] offset:15360
    s_waitcnt lgkmcnt(0)
    s_mov_b64 exec, 1
    ds_write_b32 v6, v7 offset:116
    s_mov_b64 exec, -1
Lp_41:
    ds_read_b32 v5, v6 offset:204
    s_waitcnt lgkmcnt(0)
    v_readfirstlane_b32 s57, v5
    s_cmp_ge_u32 s57, 3
    s_cbranch_scc1 Lq_42
    s_sleep 1
    s_branch Lp_41
Lq_42:
    v_add_u32 v19, 65536, v18
    s_waitcnt vmcnt(12)
    ds_write_b128 v19, v[192:195] offset:0
    ds_write_b128 v19, v[196:199] offset:1024
    ds_write_b128 v19, v[200:203] offset:2048
    ds_write_b128 v19, v[204:207] offset:3072
    s_waitcnt vmcnt(8)
    ds_write_b128 v19, v[208:211] offset:4096
    ds_write_b128 v19, v[212:215] offset:5120
    ds_write_b128 v19, v[216:219] offset:6144
    ds_write_b128 v19, v[220:223] offset:7168
    s_waitcnt vmcnt(4)
    ds_write_b128 v19, v[224:227] offset:8192
    ds_write_b128 v19, v[228:231] offset:9216
    ds_write_b128 v19, v[232:235] offset:10240
    ds_write_b128 v19, v[236:239] offset:11264
    s_waitcnt vmcnt(0)
    ds_write_b128 v19, v[240:243] offset:12288
    ds_write_b128 v19, v[244:247] offset:13312
    ds_write_b128 v19, v[248:251] offset:14336
    ds_write_b128 v19, v[252:255] offset:15360
    s_waitcnt lgkmcnt(0)
    s_mov_b64 exec, 1
    ds_write_b32 v6, v7 offset:120
    s_mov_b64 exec, -1
    s_mov_b32 s20, s12
    s_and_b32 s21, s13, 0xffff
    s_mov_b32 s22, 5242880
    s_mov_b32 s23, 0x00020000
    s_mul_i32 s45, s2, 20480
    s_and_b32 s45, s41, 3
    s_lshl_b32 s45, s45, 3
    s_and_b32 s46, s42, 7
    s_add_u32 s45, s45, s46
    s_mul_i32 s45, s45, 163840
    s_bfe_u32 s46, s42, 0x10003
    s_mul_i32 s46, s46, 640
    s_add_u32 s45, s45, s46
    v_mul_u32_u24 v2, 1280, v1
    s_add_u32 s46, s45, 0
    buffer_load_dword v20, v2, s[20:23], s46 offen
    s_add_u32 s46, s45, 128
    buffer_load_dword v21, v2, s[20:23], s46 offen
    s_add_u32 s46, s45, 256
    buffer_load_dword v22, v2, s[20:23], s46 offen
    s_add_u32 s46, s45, 384
    buffer_load_dword v23, v2, s[20:23], s46 offen
    s_add_u32 s46, s45, 512
    buffer_load_dword v24, v2, s[20:23], s46 offen
    s_add_u32 s46, s45, 81920
    buffer_load_dword v25, v2, s[20:23], s46 offen
    s_add_u32 s46, s45, 82048
    buffer_load_dword v26, v2, s[20:23], s46 offen
    s_add_u32 s46, s45, 82176
    buffer_load_dword v27, v2, s[20:23], s46 offen
    s_add_u32 s46, s45, 82304
    buffer_load_dword v28, v2, s[20:23], s46 offen
    s_add_u32 s46, s45, 82432
    buffer_load_dword v29, v2, s[20:23], s46 offen
    s_waitcnt vmcnt(0) lgkmcnt(0)
    s_endpgm
L1_lq1:
    s_waitcnt lgkmcnt(0)
    s_mov_b32 s20, s4
    s_and_b32 s21, s5, 0xffff
    s_mov_b32 s22, 983040
    s_mov_b32 s23, 0x00020000
    s_mov_b32 s24, s6
    s_and_b32 s25, s7, 0xffff
    s_mov_b32 s26, 33554432
    s_mov_b32 s27, 0x00020000
    s_mov_b32 s28, s8
    s_and_b32 s29, s9, 0xffff
    s_mov_b32 s30, 33554432
    s_mov_b32 s31, 0x00020000
    s_mov_b32 s32, s10
    s_and_b32 s33, s11, 0xffff
    s_mov_b32 s34, 5242880
    s_mov_b32 s35, 0x00020000
    s_lshl_b32 s60, s62, 19
    s_add_u32 s60, s60, s45
    s_lshl_b32 s61, s62, 7
    s_add_u32 s61, s61, s46
    s_add_u32 s62, s62, 2
    s_cmp_ge_u32 s62, 10
    s_cselect_b32 s63, 10, 0
    s_sub_u32 s62, s62, s63
    s_mov_b32 m0, 28672
    s_add_u32 s48, s60, 0
    buffer_load_dwordx4 v10, s[32:35], s48 offen  lds
    s_mov_b32 m0, 29696
    s_add_u32 s48, s60, 32768
    buffer_load_dwordx4 v10, s[32:35], s48 offen  lds
    s_mov_b32 m0, 30720
    s_add_u32 s48, s60, 65536
    buffer_load_dwordx4 v10, s[32:35], s48 offen  lds
    s_mov_b32 m0, 31744
    s_add_u32 s48, s60, 98304
    buffer_load_dwordx4 v10, s[32:35], s48 offen  lds
    s_mov_b32 m0, 32768
    s_add_u32 s48, s60, 131072
    buffer_load_dwordx4 v10, s[32:35], s48 offen  lds
    s_mov_b32 m0, 33792
    s_add_u32 s48, s60, 163840
    buffer_load_dwordx4 v10, s[32:35], s48 offen  lds
    s_mov_b32 m0, 34816
    s_add_u32 s48, s60, 196608
    buffer_load_dwordx4 v10, s[32:35], s48 offen  lds
    s_mov_b32 m0, 35840
    s_add_u32 s48, s60, 229376
    buffer_load_dwordx4 v10, s[32:35], s48 offen  lds
    s_mov_b32 m0, 36864
    s_add_u32 s48, s60, 262144
    buffer_load_dwordx4 v10, s[32:35], s48 offen  lds
    s_mov_b32 m0, 37888
    s_add_u32 s48, s60, 294912
    buffer_load_dwordx4 v10, s[32:35], s48 offen  lds
    s_mov_b32 m0, 38912
    s_add_u32 s48, s60, 327680
    buffer_load_dwordx4 v10, s[32:35], s48 offen  lds
    s_mov_b32 m0, 39936
    s_add_u32 s48, s60, 360448
    buffer_load_dwordx4 v10, s[32:35], s48 offen  lds
    s_mov_b32 m0, 40960
    s_add_u32 s48, s60, 393216
    buffer_load_dwordx4 v10, s[32:35], s48 offen  lds
    s_mov_b32 m0, 41984
    s_add_u32 s48, s60, 425984
    buffer_load_dwordx4 v10, s[32:35], s48 offen  lds
    s_mov_b32 m0, 43008
    s_add_u32 s48, s60, 458752
    buffer_load_dwordx4 v10, s[32:35], s48 offen  lds
    s_mov_b32 m0, 44032
    s_add_u32 s48, s60, 491520
    buffer_load_dwordx4 v10, s[32:35], s48 offen  lds
    s_mov_b32 m0, 45056
    s_add_u32 s48, s61, 0
    buffer_load_dwordx4 v16, s[20:23], s48 offen  lds
    s_mov_b32 m0, 46080
    s_add_u32 s48, s61, 10240
    buffer_load_dwordx4 v17, s[20:23], s48 offen  lds
    s_mov_b32 m0, 47104
    s_add_u32 s48, s61, 20480
    buffer_load_dwordx4 v16, s[20:23], s48 offen  lds
    s_mov_b32 m0, 48128
    s_add_u32 s48, s61, 30720
    buffer_load_dwordx4 v17, s[20:23], s48 offen  lds
    s_mov_b32 m0, 49152
    s_add_u32 s48, s61, 40960
    buffer_load_dwordx4 v16, s[20:23], s48 offen  lds
    s_mov_b32 m0, 50176
    s_add_u32 s48, s61, 51200
    buffer_load_dwordx4 v17, s[20:23], s48 offen  lds
    s_mov_b32 m0, 51200
    s_add_u32 s48, s61, 61440
    buffer_load_dwordx4 v16, s[20:23], s48 offen  lds
    s_mov_b32 m0, 52224
    s_add_u32 s48, s61, 71680
    buffer_load_dwordx4 v17, s[20:23], s48 offen  lds
    s_mov_b32 m0, 53248
    s_add_u32 s48, s61, 81920
    buffer_load_dwordx4 v16, s[20:23], s48 offen  lds
    s_mov_b32 m0, 54272
    s_add_u32 s48, s61, 92160
    buffer_load_dwordx4 v17, s[20:23], s48 offen  lds
    s_mov_b32 m0, 55296
    s_add_u32 s48, s61, 102400
    buffer_load_dwordx4 v16, s[20:23], s48 offen  lds
    s_mov_b32 m0, 56320
    s_add_u32 s48, s61, 112640
    buffer_load_dwordx4 v17, s[20:23], s48 offen  lds
    s_lshl_b32 s60, s62, 19
    s_add_u32 s60, s60, s45
    s_lshl_b32 s61, s62, 7
    s_add_u32 s61, s61, s46
    s_add_u32 s62, s62, 2
    s_cmp_ge_u32 s62, 10
    s_cselect_b32 s63, 10, 0
    s_sub_u32 s62, s62, s63
    s_mov_b32 m0, 86016
    s_add_u32 s48, s60, 0
    buffer_load_dwordx4 v10, s[32:35], s48 offen  lds
    s_mov_b32 m0, 87040
    s_add_u32 s48, s60, 32768
    buffer_load_dwordx4 v10, s[32:35], s48 offen  lds
    s_mov_b32 m0, 88064
    s_add_u32 s48, s60, 65536
    buffer_load_dwordx4 v10, s[32:35], s48 offen  lds
    s_mov_b32 m0, 89088
    s_add_u32 s48, s60, 98304
    buffer_load_dwordx4 v10, s[32:35], s48 offen  lds
    s_mov_b32 m0, 90112
    s_add_u32 s48, s60, 131072
    buffer_load_dwordx4 v10, s[32:35], s48 offen  lds
    s_mov_b32 m0, 91136
    s_add_u32 s48, s60, 163840
    buffer_load_dwordx4 v10, s[32:35], s48 offen  lds
    s_mov_b32 m0, 92160
    s_add_u32 s48, s60, 196608
    buffer_load_dwordx4 v10, s[32:35], s48 offen  lds
    s_mov_b32 m0, 93184
    s_add_u32 s48, s60, 229376
    buffer_load_dwordx4 v10, s[32:35], s48 offen  lds
    s_mov_b32 m0, 94208
    s_add_u32 s48, s60, 262144
    buffer_load_dwordx4 v10, s[32:35], s48 offen  lds
    s_mov_b32 m0, 95232
    s_add_u32 s48, s60, 294912
    buffer_load_dwordx4 v10, s[32:35], s48 offen  lds
    s_mov_b32 m0, 96256
    s_add_u32 s48, s60, 327680
    buffer_load_dwordx4 v10, s[32:35], s48 offen  lds
    s_mov_b32 m0, 97280
    s_add_u32 s48, s60, 360448
    buffer_load_dwordx4 v10, s[32:35], s48 offen  lds
    s_mov_b32 m0, 98304
    s_add_u32 s48, s60, 393216
    buffer_load_dwordx4 v10, s[32:35], s48 offen  lds
    s_mov_b32 m0, 99328
    s_add_u32 s48, s60, 425984
    buffer_load_dwordx4 v10, s[32:35], s48 offen  lds
    s_mov_b32 m0, 100352
    s_add_u32 s48, s60, 458752
    buffer_load_dwordx4 v10, s[32:35], s48 offen  lds
    s_mov_b32 m0, 101376
    s_add_u32 s48, s60, 491520
    buffer_load_dwordx4 v10, s[32:35], s48 offen  lds
    s_mov_b32 m0, 102400
    s_add_u32 s48, s61, 0
    buffer_load_dwordx4 v16, s[20:23], s48 offen  lds
    s_mov_b32 m0, 103424
    s_add_u32 s48, s61, 10240
    buffer_load_dwordx4 v17, s[20:23], s48 offen  lds
    s_mov_b32 m0, 104448
    s_add_u32 s48, s61, 20480
    buffer_load_dwordx4 v16, s[20:23], s48 offen  lds
    s_mov_b32 m0, 105472
    s_add_u32 s48, s61, 30720
    buffer_load_dwordx4 v17, s[20:23], s48 offen  lds
    s_mov_b32 m0, 106496
    s_add_u32 s48, s61, 40960
    buffer_load_dwordx4 v16, s[20:23], s48 offen  lds
    s_mov_b32 m0, 107520
    s_add_u32 s48, s61, 51200
    buffer_load_dwordx4 v17, s[20:23], s48 offen  lds
    s_mov_b32 m0, 108544
    s_add_u32 s48, s61, 61440
    buffer_load_dwordx4 v16, s[20:23], s48 offen  lds
    s_mov_b32 m0, 109568
    s_add_u32 s48, s61, 71680
    buffer_load_dwordx4 v17, s[20:23], s48 offen  lds
    s_mov_b32 m0, 110592
    s_add_u32 s48, s61, 81920
    buffer_load_dwordx4 v16, s[20:23], s48 offen  lds
    s_mov_b32 m0, 111616
    s_add_u32 s48, s61, 92160
    buffer_load_dwordx4 v17, s[20:23], s48 offen  lds
    s_mov_b32 m0, 112640
    s_add_u32 s48, s61, 102400
    buffer_load_dwordx4 v16, s[20:23], s48 offen  lds
    s_mov_b32 m0, 113664
    s_add_u32 s48, s61, 112640
    buffer_load_dwordx4 v17, s[20:23], s48 offen  lds
    s_barrier
    s_waitcnt vmcnt(28)
    s_mov_b64 exec, 1
    ds_write_b32 v6, v7 offset:4
    s_mov_b64 exec, -1
    ds_read_b32 v20, v6 offset:128
    s_waitcnt lgkmcnt(0)
    v_readfirstlane_b32 s57, v20
    s_cmp_ge_u32 s57, 3
    s_cbranch_scc0 Lslow_44
    s_branch Lgo_43
Lslow_44:
    s_waitcnt vmcnt(0)
    s_mov_b64 exec, 1
    ds_write_b32 v6, v7 offset:12
    s_mov_b64 exec, -1
Lp_45:
    ds_read_b32 v5, v6 offset:128
    s_waitcnt lgkmcnt(0)
    v_readfirstlane_b32 s57, v5
    s_cmp_ge_u32 s57, 3
    s_cbranch_scc0 Lp_45
Lgo_43:
    s_lshl_b32 s60, s62, 19
    s_add_u32 s60, s60, s45
    s_lshl_b32 s61, s62, 7
    s_add_u32 s61, s61, s46
    s_add_u32 s62, s62, 2
    s_cmp_ge_u32 s62, 10
    s_cselect_b32 s63, 10, 0
    s_sub_u32 s62, s62, s63
    s_mov_b32 m0, 0
    s_add_u32 s48, s60, 0
    buffer_load_dwordx4 v10, s[32:35], s48 offen  lds
    s_mov_b32 m0, 1024
    s_add_u32 s48, s60, 32768
    buffer_load_dwordx4 v10, s[32:35], s48 offen  lds
    s_mov_b32 m0, 2048
    s_add_u32 s48, s60, 65536
    buffer_load_dwordx4 v10, s[32:35], s48 offen  lds
    s_mov_b32 m0, 3072
    s_add_u32 s48, s60, 98304
    buffer_load_dwordx4 v10, s[32:35], s48 offen  lds
    s_mov_b32 m0, 4096
    s_add_u32 s48, s60, 131072
    buffer_load_dwordx4 v10, s[32:35], s48 offen  lds
    s_mov_b32 m0, 5120
    s_add_u32 s48, s60, 163840
    buffer_load_dwordx4 v10, s[32:35], s48 offen  lds
    s_mov_b32 m0, 6144
    s_add_u32 s48, s60, 196608
    buffer_load_dwordx4 v10, s[32:35], s48 offen  lds
    s_mov_b32 m0, 7168
    s_add_u32 s48, s60, 229376
    buffer_load_dwordx4 v10, s[32:35], s48 offen  lds
    s_mov_b32 m0, 8192
    s_add_u32 s48, s60, 262144
    buffer_load_dwordx4 v10, s[32:35], s48 offen  lds
    s_mov_b32 m0, 9216
    s_add_u32 s48, s60, 294912
    buffer_load_dwordx4 v10, s[32:35], s48 offen  lds
    s_mov_b32 m0, 10240
    s_add_u32 s48, s60, 327680
    buffer_load_dwordx4 v10, s[32:35], s48 offen  lds
    s_mov_b32 m0, 11264
    s_add_u32 s48, s60, 360448
    buffer_load_dwordx4 v10, s[32:35], s48 offen  lds
    s_mov_b32 m0, 12288
    s_add_u32 s48, s60, 393216
    buffer_load_dwordx4 v10, s[32:35], s48 offen  lds
    s_mov_b32 m0, 13312
    s_add_u32 s48, s60, 425984
    buffer_load_dwordx4 v10, s[32:35], s48 offen  lds
    s_mov_b32 m0, 14336
    s_add_u32 s48, s60, 458752
    buffer_load_dwordx4 v10, s[32:35], s48 offen  lds
    s_mov_b32 m0, 15360
    s_add_u32 s48, s60, 491520
    buffer_load_dwordx4 v10, s[32:35], s48 offen  lds
    s_mov_b32 m0, 16384
    s_add_u32 s48, s61, 0
    buffer_load_dwordx4 v16, s[20:23], s48 offen  lds
    s_mov_b32 m0, 17408
    s_add_u32 s48, s61, 10240
    buffer_load_dwordx4 v17, s[20:23], s48 offen  lds
    s_mov_b32 m0, 18432
    s_add_u32 s48, s61, 20480
    buffer_load_dwordx4 v16, s[20:23], s48 offen  lds
    s_mov_b32 m0, 19456
    s_add_u32 s48, s61, 30720
    buffer_load_dwordx4 v17, s[20:23], s48 offen  lds
    s_mov_b32 m0, 20480
    s_add_u32 s48, s61, 40960
    buffer_load_dwordx4 v16, s[20:23], s48 offen  lds
    s_mov_b32 m0, 21504
    s_add_u32 s48, s61, 51200
    buffer_load_dwordx4 v17, s[20:23], s48 offen  lds
    s_mov_b32 m0, 22528
    s_add_u32 s48, s61, 61440
    buffer_load_dwordx4 v16, s[20:23], s48 offen  lds
    s_mov_b32 m0, 23552
    s_add_u32 s48, s61, 71680
    buffer_load_dwordx4 v17, s[20:23], s48 offen  lds
    s_mov_b32 m0, 24576
    s_add_u32 s48, s61, 81920
    buffer_load_dwordx4 v16, s[20:23], s48 offen  lds
    s_mov_b32 m0, 25600
    s_add_u32 s48, s61, 92160
    buffer_load_dwordx4 v17, s[20:23], s48 offen  lds
    s_mov_b32 m0, 26624
    s_add_u32 s48, s61, 102400
    buffer_load_dwordx4 v16, s[20:23], s48 offen  lds
    s_mov_b32 m0, 27648
    s_add_u32 s48, s61, 112640
    buffer_load_dwordx4 v17, s[20:23], s48 offen  lds
    s_waitcnt vmcnt(28)
    s_mov_b64 exec, 1
    ds_write_b32 v6, v7 offset:12
    s_mov_b64 exec, -1
    ds_read_b32 v20, v6 offset:136
    s_waitcnt lgkmcnt(0)
    v_readfirstlane_b32 s57, v20
    s_cmp_ge_u32 s57, 3
    s_cbranch_scc0 Lslow_47
    s_branch Lgo_46
Lslow_47:
    s_waitcnt vmcnt(0)
    s_mov_b64 exec, 1
    ds_write_b32 v6, v7 offset:20
    s_mov_b64 exec, -1
Lp_48:
    ds_read_b32 v5, v6 offset:136
    s_waitcnt lgkmcnt(0)
    v_readfirstlane_b32 s57, v5
    s_cmp_ge_u32 s57, 3
    s_cbranch_scc0 Lp_48
Lgo_46:
    s_lshl_b32 s60, s62, 19
    s_add_u32 s60, s60, s45
    s_lshl_b32 s61, s62, 7
    s_add_u32 s61, s61, s46
    s_add_u32 s62, s62, 2
    s_cmp_ge_u32 s62, 10
    s_cselect_b32 s63, 10, 0
    s_sub_u32 s62, s62, s63
    s_mov_b32 m0, 57344
    s_add_u32 s48, s60, 0
    buffer_load_dwordx4 v10, s[32:35], s48 offen  lds
    s_mov_b32 m0, 58368
    s_add_u32 s48, s60, 32768
    buffer_load_dwordx4 v10, s[32:35], s48 offen  lds
    s_mov_b32 m0, 59392
    s_add_u32 s48, s60, 65536
    buffer_load_dwordx4 v10, s[32:35], s48 offen  lds
    s_mov_b32 m0, 60416
    s_add_u32 s48, s60, 98304
    buffer_load_dwordx4 v10, s[32:35], s48 offen  lds
    s_mov_b32 m0, 61440
    s_add_u32 s48, s60, 131072
    buffer_load_dwordx4 v10, s[32:35], s48 offen  lds
    s_mov_b32 m0, 62464
    s_add_u32 s48, s60, 163840
    buffer_load_dwordx4 v10, s[32:35], s48 offen  lds
    s_mov_b32 m0, 63488
    s_add_u32 s48, s60, 196608
    buffer_load_dwordx4 v10, s[32:35], s48 offen  lds
    s_mov_b32 m0, 64512
    s_add_u32 s48, s60, 229376
    buffer_load_dwordx4 v10, s[32:35], s48 offen  lds
    s_mov_b32 m0, 65536
    s_add_u32 s48, s60, 262144
    buffer_load_dwordx4 v10, s[32:35], s48 offen  lds
    s_mov_b32 m0, 66560
    s_add_u32 s48, s60, 294912
    buffer_load_dwordx4 v10, s[32:35], s48 offen  lds
    s_mov_b32 m0, 67584
    s_add_u32 s48, s60, 327680
    buffer_load_dwordx4 v10, s[32:35], s48 offen  lds
    s_mov_b32 m0, 68608
    s_add_u32 s48, s60, 360448
    buffer_load_dwordx4 v10, s[32:35], s48 offen  lds
    s_mov_b32 m0, 69632
    s_add_u32 s48, s60, 393216
    buffer_load_dwordx4 v10, s[32:35], s48 offen  lds
    s_mov_b32 m0, 70656
    s_add_u32 s48, s60, 425984
    buffer_load_dwordx4 v10, s[32:35], s48 offen  lds
    s_mov_b32 m0, 71680
    s_add_u32 s48, s60, 458752
    buffer_load_dwordx4 v10, s[32:35], s48 offen  lds
    s_mov_b32 m0, 72704
    s_add_u32 s48, s60, 491520
    buffer_load_dwordx4 v10, s[32:35], s48 offen  lds
    s_mov_b32 m0, 73728
    s_add_u32 s48, s61, 0
    buffer_load_dwordx4 v16, s[20:23], s48 offen  lds
    s_mov_b32 m0, 74752
    s_add_u32 s48, s61, 10240
    buffer_load_dwordx4 v17, s[20:23], s48 offen  lds
    s_mov_b32 m0, 75776
    s_add_u32 s48, s61, 20480
    buffer_load_dwordx4 v16, s[20:23], s48 offen  lds
    s_mov_b32 m0, 76800
    s_add_u32 s48, s61, 30720
    buffer_load_dwordx4 v17, s[20:23], s48 offen  lds
    s_mov_b32 m0, 77824
    s_add_u32 s48, s61, 40960
    buffer_load_dwordx4 v16, s[20:23], s48 offen  lds
    s_mov_b32 m0, 78848
    s_add_u32 s48, s61, 51200
    buffer_load_dwordx4 v17, s[20:23], s48 offen  lds
    s_mov_b32 m0, 79872
    s_add_u32 s48, s61, 61440
    buffer_load_dwordx4 v16, s[20:23], s48 offen  lds
    s_mov_b32 m0, 80896
    s_add_u32 s48, s61, 71680
    buffer_load_dwordx4 v17, s[20:23], s48 offen  lds
    s_mov_b32 m0, 81920
    s_add_u32 s48, s61, 81920
    buffer_load_dwordx4 v16, s[20:23], s48 offen  lds
    s_mov_b32 m0, 82944
    s_add_u32 s48, s61, 92160
    buffer_load_dwordx4 v17, s[20:23], s48 offen  lds
    s_mov_b32 m0, 83968
    s_add_u32 s48, s61, 102400
    buffer_load_dwordx4 v16, s[20:23], s48 offen  lds
    s_mov_b32 m0, 84992
    s_add_u32 s48, s61, 112640
    buffer_load_dwordx4 v17, s[20:23], s48 offen  lds
    s_waitcnt vmcnt(28)
    s_mov_b64 exec, 1
    ds_write_b32 v6, v7 offset:20
    s_mov_b64 exec, -1
    ds_read_b32 v20, v6 offset:144
    s_waitcnt lgkmcnt(0)
    v_readfirstlane_b32 s57, v20
    s_cmp_ge_u32 s57, 3
    s_cbranch_scc0 Lslow_50
    s_branch Lgo_49
Lslow_50:
    s_waitcnt vmcnt(0)
    s_mov_b64 exec, 1
    ds_write_b32 v6, v7 offset:28
    s_mov_b64 exec, -1
Lp_51:
    ds_read_b32 v5, v6 offset:144
    s_waitcnt lgkmcnt(0)
    v_readfirstlane_b32 s57, v5
    s_cmp_ge_u32 s57, 3
    s_cbranch_scc0 Lp_51
Lgo_49:
    s_lshl_b32 s60, s62, 19
    s_add_u32 s60, s60, s45
    s_lshl_b32 s61, s62, 7
    s_add_u32 s61, s61, s46
    s_add_u32 s62, s62, 2
    s_cmp_ge_u32 s62, 10
    s_cselect_b32 s63, 10, 0
    s_sub_u32 s62, s62, s63
    s_mov_b32 m0, 114688
    s_add_u32 s48, s60, 0
    buffer_load_dwordx4 v10, s[32:35], s48 offen  lds
    s_mov_b32 m0, 115712
    s_add_u32 s48, s60, 32768
    buffer_load_dwordx4 v10, s[32:35], s48 offen  lds
    s_mov_b32 m0, 116736
    s_add_u32 s48, s60, 65536
    buffer_load_dwordx4 v10, s[32:35], s48 offen  lds
    s_mov_b32 m0, 117760
    s_add_u32 s48, s60, 98304
    buffer_load_dwordx4 v10, s[32:35], s48 offen  lds
    s_mov_b32 m0, 118784
    s_add_u32 s48, s60, 131072
    buffer_load_dwordx4 v10, s[32:35], s48 offen  lds
    s_mov_b32 m0, 119808
    s_add_u32 s48, s60, 163840
    buffer_load_dwordx4 v10, s[32:35], s48 offen  lds
    s_mov_b32 m0, 120832
    s_add_u32 s48, s60, 196608
    buffer_load_dwordx4 v10, s[32:35], s48 offen  lds
    s_mov_b32 m0, 121856
    s_add_u32 s48, s60, 229376
    buffer_load_dwordx4 v10, s[32:35], s48 offen  lds
    s_mov_b32 m0, 122880
    s_add_u32 s48, s60, 262144
    buffer_load_dwordx4 v10, s[32:35], s48 offen  lds
    s_mov_b32 m0, 123904
    s_add_u32 s48, s60, 294912
    buffer_load_dwordx4 v10, s[32:35], s48 offen  lds
    s_mov_b32 m0, 124928
    s_add_u32 s48, s60, 327680
    buffer_load_dwordx4 v10, s[32:35], s48 offen  lds
    s_mov_b32 m0, 125952
    s_add_u32 s48, s60, 360448
    buffer_load_dwordx4 v10, s[32:35], s48 offen  lds
    s_mov_b32 m0, 126976
    s_add_u32 s48, s60, 393216
    buffer_load_dwordx4 v10, s[32:35], s48 offen  lds
    s_mov_b32 m0, 128000
    s_add_u32 s48, s60, 425984
    buffer_load_dwordx4 v10, s[32:35], s48 offen  lds
    s_mov_b32 m0, 129024
    s_add_u32 s48, s60, 458752
    buffer_load_dwordx4 v10, s[32:35], s48 offen  lds
    s_mov_b32 m0, 130048
    s_add_u32 s48, s60, 491520
    buffer_load_dwordx4 v10, s[32:35], s48 offen  lds
    s_mov_b32 m0, 131072
    s_add_u32 s48, s61, 0
    buffer_load_dwordx4 v16, s[20:23], s48 offen  lds
    s_mov_b32 m0, 132096
    s_add_u32 s48, s61, 10240
    buffer_load_dwordx4 v17, s[20:23], s48 offen  lds
    s_mov_b32 m0, 133120
    s_add_u32 s48, s61, 20480
    buffer_load_dwordx4 v16, s[20:23], s48 offen  lds
    s_mov_b32 m0, 134144
    s_add_u32 s48, s61, 30720
    buffer_load_dwordx4 v17, s[20:23], s48 offen  lds
    s_mov_b32 m0, 135168
    s_add_u32 s48, s61, 40960
    buffer_load_dwordx4 v16, s[20:23], s48 offen  lds
    s_mov_b32 m0, 136192
    s_add_u32 s48, s61, 51200
    buffer_load_dwordx4 v17, s[20:23], s48 offen  lds
    s_mov_b32 m0, 137216
    s_add_u32 s48, s61, 61440
    buffer_load_dwordx4 v16, s[20:23], s48 offen  lds
    s_mov_b32 m0, 138240
    s_add_u32 s48, s61, 71680
    buffer_load_dwordx4 v17, s[20:23], s48 offen  lds
    s_mov_b32 m0, 139264
    s_add_u32 s48, s61, 81920
    buffer_load_dwordx4 v16, s[20:23], s48 offen  lds
    s_mov_b32 m0, 140288
    s_add_u32 s48, s61, 92160
    buffer_load_dwordx4 v17, s[20:23], s48 offen  lds
    s_mov_b32 m0, 141312
    s_add_u32 s48, s61, 102400
    buffer_load_dwordx4 v16, s[20:23], s48 offen  lds
    s_mov_b32 m0, 142336
    s_add_u32 s48, s61, 112640
    buffer_load_dwordx4 v17, s[20:23], s48 offen  lds
    v_mov_b32 v5, 3
    s_mov_b64 exec, 1
    ds_add_u32 v6, v5 offset:256
    s_mov_b64 exec, -1
    s_waitcnt vmcnt(28)
    s_mov_b64 exec, 1
    ds_write_b32 v6, v7 offset:28
    s_mov_b64 exec, -1
    s_waitcnt vmcnt(0)
    s_mov_b64 exec, 1
    ds_write_b32 v6, v7 offset:36
    s_mov_b64 exec, -1
Lp_52:
    ds_read_b32 v5, v6 offset:256
    s_waitcnt lgkmcnt(0)
    v_readfirstlane_b32 s57, v5
    s_cmp_ge_u32 s57, 11
    s_cbranch_scc1 Lq_53
    s_sleep 2
    s_branch Lp_52
Lq_53:
    s_add_u32 s48, s47, 98304
    buffer_load_dwordx4 v[64:67], v12, s[24:27], s48 offen offset:0 nt
    buffer_load_dwordx4 v[68:71], v13, s[24:27], s48 offen offset:1024 nt
    buffer_load_dwordx4 v[72:75], v14, s[24:27], s48 offen offset:2048 nt
    buffer_load_dwordx4 v[76:79], v15, s[24:27], s48 offen offset:3072 nt
    s_add_u32 s48, s47, 102400
    buffer_load_dwordx4 v[80:83], v12, s[24:27], s48 offen offset:0 nt
    buffer_load_dwordx4 v[84:87], v13, s[24:27], s48 offen offset:1024 nt
    buffer_load_dwordx4 v[88:91], v14, s[24:27], s48 offen offset:2048 nt
    buffer_load_dwordx4 v[92:95], v15, s[24:27], s48 offen offset:3072 nt
    s_add_u32 s48, s47, 106496
    buffer_load_dwordx4 v[96:99], v12, s[24:27], s48 offen offset:0 nt
    buffer_load_dwordx4 v[100:103], v13, s[24:27], s48 offen offset:1024 nt
    buffer_load_dwordx4 v[104:107], v14, s[24:27], s48 offen offset:2048 nt
    buffer_load_dwordx4 v[108:111], v15, s[24:27], s48 offen offset:3072 nt
    s_add_u32 s48, s47, 110592
    buffer_load_dwordx4 v[112:115], v12, s[24:27], s48 offen offset:0 nt
    buffer_load_dwordx4 v[116:119], v13, s[24:27], s48 offen offset:1024 nt
    buffer_load_dwordx4 v[120:123], v14, s[24:27], s48 offen offset:2048 nt
    buffer_load_dwordx4 v[124:127], v15, s[24:27], s48 offen offset:3072 nt
Lp_54:
    ds_read_b32 v5, v6 offset:256
    s_waitcnt lgkmcnt(0)
    v_readfirstlane_b32 s57, v5
    s_cmp_ge_u32 s57, 13
    s_cbranch_scc1 Lq_55
    s_sleep 2
    s_branch Lp_54
Lq_55:
    s_add_u32 s48, s47, 114688
    buffer_load_dwordx4 v[128:131], v12, s[24:27], s48 offen offset:0 nt
    buffer_load_dwordx4 v[132:135], v13, s[24:27], s48 offen offset:1024 nt
    buffer_load_dwordx4 v[136:139], v14, s[24:27], s48 offen offset:2048 nt
    buffer_load_dwordx4 v[140:143], v15, s[24:27], s48 offen offset:3072 nt
    s_add_u32 s48, s47, 118784
    buffer_load_dwordx4 v[144:147], v12, s[24:27], s48 offen offset:0 nt
    buffer_load_dwordx4 v[148:151], v13, s[24:27], s48 offen offset:1024 nt
    buffer_load_dwordx4 v[152:155], v14, s[24:27], s48 offen offset:2048 nt
    buffer_load_dwordx4 v[156:159], v15, s[24:27], s48 offen offset:3072 nt
    s_add_u32 s48, s47, 122880
    buffer_load_dwordx4 v[160:163], v12, s[24:27], s48 offen offset:0 nt
    buffer_load_dwordx4 v[164:167], v13, s[24:27], s48 offen offset:1024 nt
    buffer_load_dwordx4 v[168:171], v14, s[24:27], s48 offen offset:2048 nt
    buffer_load_dwordx4 v[172:175], v15, s[24:27], s48 offen offset:3072 nt
    s_add_u32 s48, s47, 126976
    buffer_load_dwordx4 v[176:179], v12, s[24:27], s48 offen offset:0 nt
    buffer_load_dwordx4 v[180:183], v13, s[24:27], s48 offen offset:1024 nt
    buffer_load_dwordx4 v[184:187], v14, s[24:27], s48 offen offset:2048 nt
    buffer_load_dwordx4 v[188:191], v15, s[24:27], s48 offen offset:3072 nt
    s_waitcnt vmcnt(16)
    s_mov_b64 exec, 1
    ds_add_u32 v6, v7 offset:256
    s_mov_b64 exec, -1
Lp_56:
    ds_read_b32 v5, v6 offset:256
    s_waitcnt lgkmcnt(0)
    v_readfirstlane_b32 s57, v5
    s_cmp_ge_u32 s57, 15
    s_cbranch_scc1 Lq_57
    s_sleep 2
    s_branch Lp_56
Lq_57:
    s_add_u32 s48, s47, 114688
    buffer_load_dwordx4 v[192:195], v11, s[28:31], s48 offen offset:0 nt
    buffer_load_dwordx4 v[196:199], v11, s[28:31], s48 offen offset:1024 nt
    buffer_load_dwordx4 v[200:203], v11, s[28:31], s48 offen offset:2048 nt
    buffer_load_dwordx4 v[204:207], v11, s[28:31], s48 offen offset:3072 nt
    s_add_u32 s48, s47, 118784
    buffer_load_dwordx4 v[208:211], v11, s[28:31], s48 offen offset:0 nt
    buffer_load_dwordx4 v[212:215], v11, s[28:31], s48 offen offset:1024 nt
    buffer_load_dwordx4 v[216:219], v11, s[28:31], s48 offen offset:2048 nt
    buffer_load_dwordx4 v[220:223], v11, s[28:31], s48 offen offset:3072 nt
    s_add_u32 s48, s47, 122880
    buffer_load_dwordx4 v[224:227], v11, s[28:31], s48 offen offset:0 nt
    buffer_load_dwordx4 v[228:231], v11, s[28:31], s48 offen offset:1024 nt
    buffer_load_dwordx4 v[232:235], v11, s[28:31], s48 offen offset:2048 nt
    buffer_load_dwordx4 v[236:239], v11, s[28:31], s48 offen offset:3072 nt
    s_add_u32 s48, s47, 126976
    buffer_load_dwordx4 v[240:243], v11, s[28:31], s48 offen offset:0 nt
    buffer_load_dwordx4 v[244:247], v11, s[28:31], s48 offen offset:1024 nt
    buffer_load_dwordx4 v[248:251], v11, s[28:31], s48 offen offset:2048 nt
    buffer_load_dwordx4 v[252:255], v11, s[28:31], s48 offen offset:3072 nt
Lp_58:
    ds_read_b32 v5, v6 offset:224
    s_waitcnt lgkmcnt(0)
    v_readfirstlane_b32 s57, v5
    s_cmp_ge_u32 s57, 3
    s_cbranch_scc1 Lq_59
    s_sleep 1
    s_branch Lp_58
Lq_59:
    v_add_u32 v19, 16384, v18
    ds_write_b128 v19, v[64:67] offset:0
    ds_write_b128 v19, v[68:71] offset:1024
    ds_write_b128 v19, v[72:75] offset:2048
    ds_write_b128 v19, v[76:79] offset:3072
    ds_write_b128 v19, v[80:83] offset:4096
    ds_write_b128 v19, v[84:87] offset:5120
    ds_write_b128 v19, v[88:91] offset:6144
    ds_write_b128 v19, v[92:95] offset:7168
    ds_write_b128 v19, v[96:99] offset:8192
    ds_write_b128 v19, v[100:103] offset:9216
    ds_write_b128 v19, v[104:107] offset:10240
    ds_write_b128 v19, v[108:111] offset:11264
    ds_write_b128 v19, v[112:115] offset:12288
    ds_write_b128 v19, v[116:119] offset:13312
    ds_write_b128 v19, v[120:123] offset:14336
    ds_write_b128 v19, v[124:127] offset:15360
    s_waitcnt lgkmcnt(0)
    s_mov_b64 exec, 1
    ds_write_b32 v6, v7 offset:88
    s_mov_b64 exec, -1
Lp_60:
    ds_read_b32 v5, v6 offset:228
    s_waitcnt lgkmcnt(0)
    v_readfirstlane_b32 s57, v5
    s_cmp_ge_u32 s57, 3
    s_cbranch_scc1 Lq_61
    s_sleep 1
    s_branch Lp_60
Lq_61:
    v_add_u32 v19, 49152, v18
    s_waitcnt vmcnt(28)
    ds_write_b128 v19, v[128:131] offset:0
    ds_write_b128 v19, v[132:135] offset:1024
    ds_write_b128 v19, v[136:139] offset:2048
    ds_write_b128 v19, v[140:143] offset:3072
    s_waitcnt vmcnt(24)
    ds_write_b128 v19, v[144:147] offset:4096
    ds_write_b128 v19, v[148:151] offset:5120
    ds_write_b128 v19, v[152:155] offset:6144
    ds_write_b128 v19, v[156:159] offset:7168
    s_waitcnt vmcnt(20)
    ds_write_b128 v19, v[160:163] offset:8192
    ds_write_b128 v19, v[164:167] offset:9216
    ds_write_b128 v19, v[168:171] offset:10240
    ds_write_b128 v19, v[172:175] offset:11264
    s_waitcnt vmcnt(16)
    ds_write_b128 v19, v[176:179] offset:12288
    ds_write_b128 v19, v[180:183] offset:13312
    ds_write_b128 v19, v[184:187] offset:14336
    ds_write_b128 v19, v[188:191] offset:15360
    s_waitcnt lgkmcnt(0)
    s_mov_b64 exec, 1
    ds_write_b32 v6, v7 offset:92
    s_mov_b64 exec, -1
Lp_62:
    ds_read_b32 v5, v6 offset:232
    s_waitcnt lgkmcnt(0)
    v_readfirstlane_b32 s57, v5
    s_cmp_ge_u32 s57, 3
    s_cbranch_scc1 Lq_63
    s_sleep 1
    s_branch Lp_62
Lq_63:
    v_add_u32 v19, 81920, v18
    s_waitcnt vmcnt(12)
    ds_write_b128 v19, v[192:195] offset:0
    ds_write_b128 v19, v[196:199] offset:1024
    ds_write_b128 v19, v[200:203] offset:2048
    ds_write_b128 v19, v[204:207] offset:3072
    s_waitcnt vmcnt(8)
    ds_write_b128 v19, v[208:211] offset:4096
    ds_write_b128 v19, v[212:215] offset:5120
    ds_write_b128 v19, v[216:219] offset:6144
    ds_write_b128 v19, v[220:223] offset:7168
    s_waitcnt vmcnt(4)
    ds_write_b128 v19, v[224:227] offset:8192
    ds_write_b128 v19, v[228:231] offset:9216
    ds_write_b128 v19, v[232:235] offset:10240
    ds_write_b128 v19, v[236:239] offset:11264
    s_waitcnt vmcnt(0)
    ds_write_b128 v19, v[240:243] offset:12288
    ds_write_b128 v19, v[244:247] offset:13312
    ds_write_b128 v19, v[248:251] offset:14336
    ds_write_b128 v19, v[252:255] offset:15360
    s_waitcnt lgkmcnt(0)
    s_mov_b64 exec, 1
    ds_write_b32 v6, v7 offset:124
    s_mov_b64 exec, -1
    s_waitcnt vmcnt(0) lgkmcnt(0)
    s_endpgm
L1_lk0:
    s_waitcnt lgkmcnt(0)
    s_mov_b32 s24, s6
    s_and_b32 s25, s7, 0xffff
    s_mov_b32 s26, 33554432
    s_mov_b32 s27, 0x00020000
    s_mov_b32 s28, s8
    s_and_b32 s29, s9, 0xffff
    s_mov_b32 s30, 33554432
    s_mov_b32 s31, 0x00020000
    s_mov_b32 m0, 143360
    s_add_u32 s48, s47, 0
    buffer_load_dwordx4 v12, s[24:27], s48 offen offset:0 nt lds
    buffer_load_dwordx4 v13, s[24:27], s48 offen offset:1024 nt lds
    buffer_load_dwordx4 v14, s[24:27], s48 offen offset:2048 nt lds
    buffer_load_dwordx4 v15, s[24:27], s48 offen offset:3072 nt lds
    s_mov_b32 m0, 147456
    s_add_u32 s48, s47, 4096
    buffer_load_dwordx4 v12, s[24:27], s48 offen offset:0 nt lds
    buffer_load_dwordx4 v13, s[24:27], s48 offen offset:1024 nt lds
    buffer_load_dwordx4 v14, s[24:27], s48 offen offset:2048 nt lds
    buffer_load_dwordx4 v15, s[24:27], s48 offen offset:3072 nt lds
    s_mov_b32 m0, 151552
    s_add_u32 s48, s47, 8192
    buffer_load_dwordx4 v12, s[24:27], s48 offen offset:0 nt lds
    buffer_load_dwordx4 v13, s[24:27], s48 offen offset:1024 nt lds
    buffer_load_dwordx4 v14, s[24:27], s48 offen offset:2048 nt lds
    buffer_load_dwordx4 v15, s[24:27], s48 offen offset:3072 nt lds
    s_mov_b32 m0, 155648
    s_add_u32 s48, s47, 12288
    buffer_load_dwordx4 v12, s[24:27], s48 offen offset:0 nt lds
    buffer_load_dwordx4 v13, s[24:27], s48 offen offset:1024 nt lds
    buffer_load_dwordx4 v14, s[24:27], s48 offen offset:2048 nt lds
    buffer_load_dwordx4 v15, s[24:27], s48 offen offset:3072 nt lds
    s_barrier
    s_waitcnt vmcnt(0)
    s_mov_b64 exec, 1
    ds_write_b32 v6, v7 offset:64
    s_mov_b64 exec, -1
    s_mov_b64 exec, 1
    ds_add_u32 v6, v7 offset:256
    s_mov_b64 exec, -1
Lp_64:
    ds_read_b32 v5, v6 offset:256
    s_waitcnt lgkmcnt(0)
    v_readfirstlane_b32 s57, v5
    s_cmp_ge_u32 s57, 1
    s_cbranch_scc1 Lq_65
    s_sleep 2
    s_branch Lp_64
Lq_65:
    s_add_u32 s48, s47, 16384
    buffer_load_dwordx4 v[64:67], v12, s[24:27], s48 offen offset:0 nt
    buffer_load_dwordx4 v[68:71], v13, s[24:27], s48 offen offset:1024 nt
    buffer_load_dwordx4 v[72:75], v14, s[24:27], s48 offen offset:2048 nt
    buffer_load_dwordx4 v[76:79], v15, s[24:27], s48 offen offset:3072 nt
    s_add_u32 s48, s47, 20480
    buffer_load_dwordx4 v[80:83], v12, s[24:27], s48 offen offset:0 nt
    buffer_load_dwordx4 v[84:87], v13, s[24:27], s48 offen offset:1024 nt
    buffer_load_dwordx4 v[88:91], v14, s[24:27], s48 offen offset:2048 nt
    buffer_load_dwordx4 v[92:95], v15, s[24:27], s48 offen offset:3072 nt
    s_add_u32 s48, s47, 24576
    buffer_load_dwordx4 v[96:99], v12, s[24:27], s48 offen offset:0 nt
    buffer_load_dwordx4 v[100:103], v13, s[24:27], s48 offen offset:1024 nt
    buffer_load_dwordx4 v[104:107], v14, s[24:27], s48 offen offset:2048 nt
    buffer_load_dwordx4 v[108:111], v15, s[24:27], s48 offen offset:3072 nt
    s_add_u32 s48, s47, 28672
    buffer_load_dwordx4 v[112:115], v12, s[24:27], s48 offen offset:0 nt
    buffer_load_dwordx4 v[116:119], v13, s[24:27], s48 offen offset:1024 nt
    buffer_load_dwordx4 v[120:123], v14, s[24:27], s48 offen offset:2048 nt
    buffer_load_dwordx4 v[124:127], v15, s[24:27], s48 offen offset:3072 nt
    s_waitcnt vmcnt(0)
    s_mov_b64 exec, 1
    ds_add_u32 v6, v7 offset:256
    s_mov_b64 exec, -1
Lp_66:
    ds_read_b32 v5, v6 offset:256
    s_waitcnt lgkmcnt(0)
    v_readfirstlane_b32 s57, v5
    s_cmp_ge_u32 s57, 4
    s_cbranch_scc1 Lq_67
    s_sleep 2
    s_branch Lp_66
Lq_67:
    s_add_u32 s48, s47, 16384
    buffer_load_dwordx4 v[128:131], v11, s[28:31], s48 offen offset:0 nt
    buffer_load_dwordx4 v[132:135], v11, s[28:31], s48 offen offset:1024 nt
    buffer_load_dwordx4 v[136:139], v11, s[28:31], s48 offen offset:2048 nt
    buffer_load_dwordx4 v[140:143], v11, s[28:31], s48 offen offset:3072 nt
    s_add_u32 s48, s47, 20480
    buffer_load_dwordx4 v[144:147], v11, s[28:31], s48 offen offset:0 nt
    buffer_load_dwordx4 v[148:151], v11, s[28:31], s48 offen offset:1024 nt
    buffer_load_dwordx4 v[152:155], v11, s[28:31], s48 offen offset:2048 nt
    buffer_load_dwordx4 v[156:159], v11, s[28:31], s48 offen offset:3072 nt
    s_add_u32 s48, s47, 24576
    buffer_load_dwordx4 v[160:163], v11, s[28:31], s48 offen offset:0 nt
    buffer_load_dwordx4 v[164:167], v11, s[28:31], s48 offen offset:1024 nt
    buffer_load_dwordx4 v[168:171], v11, s[28:31], s48 offen offset:2048 nt
    buffer_load_dwordx4 v[172:175], v11, s[28:31], s48 offen offset:3072 nt
    s_add_u32 s48, s47, 28672
    buffer_load_dwordx4 v[176:179], v11, s[28:31], s48 offen offset:0 nt
    buffer_load_dwordx4 v[180:183], v11, s[28:31], s48 offen offset:1024 nt
    buffer_load_dwordx4 v[184:187], v11, s[28:31], s48 offen offset:2048 nt
    buffer_load_dwordx4 v[188:191], v11, s[28:31], s48 offen offset:3072 nt
    s_waitcnt vmcnt(0)
    s_mov_b64 exec, 1
    ds_add_u32 v6, v7 offset:256
    s_mov_b64 exec, -1
Lp_68:
    ds_read_b32 v5, v6 offset:148
    s_waitcnt lgkmcnt(0)
    v_readfirstlane_b32 s57, v5
    s_cmp_ge_u32 s57, 3
    s_cbranch_scc1 Lq_69
    s_sleep 1
    s_branch Lp_68
Lq_69:
    v_add_u32 v19, 0, v18
    ds_write_b128 v19, v[64:67] offset:0
    ds_write_b128 v19, v[68:71] offset:1024
    ds_write_b128 v19, v[72:75] offset:2048
    ds_write_b128 v19, v[76:79] offset:3072
    ds_write_b128 v19, v[80:83] offset:4096
    ds_write_b128 v19, v[84:87] offset:5120
    ds_write_b128 v19, v[88:91] offset:6144
    ds_write_b128 v19, v[92:95] offset:7168
    ds_write_b128 v19, v[96:99] offset:8192
    ds_write_b128 v19, v[100:103] offset:9216
    ds_write_b128 v19, v[104:107] offset:10240
    ds_write_b128 v19, v[108:111] offset:11264
    ds_write_b128 v19, v[112:115] offset:12288
    ds_write_b128 v19, v[116:119] offset:13312
    ds_write_b128 v19, v[120:123] offset:14336
    ds_write_b128 v19, v[124:127] offset:15360
    s_waitcnt lgkmcnt(0)
    s_mov_b64 exec, 1
    ds_write_b32 v6, v7 offset:68
    s_mov_b64 exec, -1
Lp_70:
    ds_read_b32 v5, v6 offset:256
    s_waitcnt lgkmcnt(0)
    v_readfirstlane_b32 s57, v5
    s_cmp_ge_u32 s57, 7
    s_cbranch_scc1 Lq_71
    s_sleep 2
    s_branch Lp_70
Lq_71:
    s_add_u32 s48, s47, 65536
    buffer_load_dwordx4 v[192:195], v12, s[24:27], s48 offen offset:0 nt
    buffer_load_dwordx4 v[196:199], v13, s[24:27], s48 offen offset:1024 nt
    buffer_load_dwordx4 v[200:203], v14, s[24:27], s48 offen offset:2048 nt
    buffer_load_dwordx4 v[204:207], v15, s[24:27], s48 offen offset:3072 nt
    s_add_u32 s48, s47, 69632
    buffer_load_dwordx4 v[208:211], v12, s[24:27], s48 offen offset:0 nt
    buffer_load_dwordx4 v[212:215], v13, s[24:27], s48 offen offset:1024 nt
    buffer_load_dwordx4 v[216:219], v14, s[24:27], s48 offen offset:2048 nt
    buffer_load_dwordx4 v[220:223], v15, s[24:27], s48 offen offset:3072 nt
    s_add_u32 s48, s47, 73728
    buffer_load_dwordx4 v[224:227], v12, s[24:27], s48 offen offset:0 nt
    buffer_load_dwordx4 v[228:231], v13, s[24:27], s48 offen offset:1024 nt
    buffer_load_dwordx4 v[232:235], v14, s[24:27], s48 offen offset:2048 nt
    buffer_load_dwordx4 v[236:239], v15, s[24:27], s48 offen offset:3072 nt
    s_add_u32 s48, s47, 77824
    buffer_load_dwordx4 v[240:243], v12, s[24:27], s48 offen offset:0 nt
    buffer_load_dwordx4 v[244:247], v13, s[24:27], s48 offen offset:1024 nt
    buffer_load_dwordx4 v[248:251], v14, s[24:27], s48 offen offset:2048 nt
    buffer_load_dwordx4 v[252:255], v15, s[24:27], s48 offen offset:3072 nt
Lp_72:
    ds_read_b32 v5, v6 offset:152
    s_waitcnt lgkmcnt(0)
    v_readfirstlane_b32 s57, v5
    s_cmp_ge_u32 s57, 3
    s_cbranch_scc1 Lq_73
    s_sleep 1
    s_branch Lp_72
Lq_73:
Lp_74:
    ds_read_b32 v5, v6 offset:156
    s_waitcnt lgkmcnt(0)
    v_readfirstlane_b32 s57, v5
    s_cmp_ge_u32 s57, 3
    s_cbranch_scc1 Lq_75
    s_sleep 1
    s_branch Lp_74
Lq_75:
    v_add_u32 v19, 49152, v18
    ds_write_b128 v19, v[128:131] offset:0
    ds_write_b128 v19, v[132:135] offset:1024
    ds_write_b128 v19, v[136:139] offset:2048
    ds_write_b128 v19, v[140:143] offset:3072
    ds_write_b128 v19, v[144:147] offset:4096
    ds_write_b128 v19, v[148:151] offset:5120
    ds_write_b128 v19, v[152:155] offset:6144
    ds_write_b128 v19, v[156:159] offset:7168
    ds_write_b128 v19, v[160:163] offset:8192
    ds_write_b128 v19, v[164:167] offset:9216
    ds_write_b128 v19, v[168:171] offset:10240
    ds_write_b128 v19, v[172:175] offset:11264
    ds_write_b128 v19, v[176:179] offset:12288
    ds_write_b128 v19, v[180:183] offset:13312
    ds_write_b128 v19, v[184:187] offset:14336
    ds_write_b128 v19, v[188:191] offset:15360
    s_waitcnt lgkmcnt(0)
    s_mov_b64 exec, 1
    ds_write_b32 v6, v7 offset:100
    s_mov_b64 exec, -1
    s_waitcnt vmcnt(0)
    s_mov_b64 exec, 1
    ds_add_u32 v6, v7 offset:256
    s_mov_b64 exec, -1
Lp_76:
    ds_read_b32 v5, v6 offset:160
    s_waitcnt lgkmcnt(0)
    v_readfirstlane_b32 s57, v5
    s_cmp_ge_u32 s57, 3
    s_cbranch_scc1 Lq_77
    s_sleep 1
    s_branch Lp_76
Lq_77:
Lp_78:
    ds_read_b32 v5, v6 offset:160
    s_waitcnt lgkmcnt(0)
    v_readfirstlane_b32 s57, v5
    s_cmp_ge_u32 s57, 3
    s_cbranch_scc1 Lq_79
    s_sleep 1
    s_branch Lp_78
Lq_79:
    v_add_u32 v19, 98304, v18
    ds_write_b128 v19, v[192:195] offset:0
    ds_write_b128 v19, v[196:199] offset:1024
    ds_write_b128 v19, v[200:203] offset:2048
    ds_write_b128 v19, v[204:207] offset:3072
    ds_write_b128 v19, v[208:211] offset:4096
    ds_write_b128 v19, v[212:215] offset:5120
    ds_write_b128 v19, v[216:219] offset:6144
    ds_write_b128 v19, v[220:223] offset:7168
    ds_write_b128 v19, v[224:227] offset:8192
    ds_write_b128 v19, v[228:231] offset:9216
    ds_write_b128 v19, v[232:235] offset:10240
    ds_write_b128 v19, v[236:239] offset:11264
    ds_write_b128 v19, v[240:243] offset:12288
    ds_write_b128 v19, v[244:247] offset:13312
    ds_write_b128 v19, v[248:251] offset:14336
    ds_write_b128 v19, v[252:255] offset:15360
    s_waitcnt lgkmcnt(0)
    s_mov_b64 exec, 1
    ds_write_b32 v6, v7 offset:80
    s_mov_b64 exec, -1
    s_waitcnt vmcnt(0) lgkmcnt(0)
    s_endpgm
L1_lk1:
    s_waitcnt lgkmcnt(0)
    s_mov_b32 s24, s6
    s_and_b32 s25, s7, 0xffff
    s_mov_b32 s26, 33554432
    s_mov_b32 s27, 0x00020000
    s_mov_b32 s28, s8
    s_and_b32 s29, s9, 0xffff
    s_mov_b32 s30, 33554432
    s_mov_b32 s31, 0x00020000
    s_barrier
Lp_80:
    ds_read_b32 v5, v6 offset:256
    s_waitcnt lgkmcnt(0)
    v_readfirstlane_b32 s57, v5
    s_cmp_ge_u32 s57, 2
    s_cbranch_scc1 Lq_81
    s_sleep 2
    s_branch Lp_80
Lq_81:
    s_add_u32 s48, s47, 0
    buffer_load_dwordx4 v[64:67], v11, s[28:31], s48 offen offset:0 nt
    buffer_load_dwordx4 v[68:71], v11, s[28:31], s48 offen offset:1024 nt
    buffer_load_dwordx4 v[72:75], v11, s[28:31], s48 offen offset:2048 nt
    buffer_load_dwordx4 v[76:79], v11, s[28:31], s48 offen offset:3072 nt
    s_add_u32 s48, s47, 4096
    buffer_load_dwordx4 v[80:83], v11, s[28:31], s48 offen offset:0 nt
    buffer_load_dwordx4 v[84:87], v11, s[28:31], s48 offen offset:1024 nt
    buffer_load_dwordx4 v[88:91], v11, s[28:31], s48 offen offset:2048 nt
    buffer_load_dwordx4 v[92:95], v11, s[28:31], s48 offen offset:3072 nt
    s_add_u32 s48, s47, 8192
    buffer_load_dwordx4 v[96:99], v11, s[28:31], s48 offen offset:0 nt
    buffer_load_dwordx4 v[100:103], v11, s[28:31], s48 offen offset:1024 nt
    buffer_load_dwordx4 v[104:107], v11, s[28:31], s48 offen offset:2048 nt
    buffer_load_dwordx4 v[108:111], v11, s[28:31], s48 offen offset:3072 nt
    s_add_u32 s48, s47, 12288
    buffer_load_dwordx4 v[112:115], v11, s[28:31], s48 offen offset:0 nt
    buffer_load_dwordx4 v[116:119], v11, s[28:31], s48 offen offset:1024 nt
    buffer_load_dwordx4 v[120:123], v11, s[28:31], s48 offen offset:2048 nt
    buffer_load_dwordx4 v[124:127], v11, s[28:31], s48 offen offset:3072 nt
    s_waitcnt vmcnt(0)
    s_mov_b64 exec, 1
    ds_add_u32 v6, v7 offset:256
    s_mov_b64 exec, -1
Lp_82:
    ds_read_b32 v5, v6 offset:256
    s_waitcnt lgkmcnt(0)
    v_readfirstlane_b32 s57, v5
    s_cmp_ge_u32 s57, 5
    s_cbranch_scc1 Lq_83
    s_sleep 2
    s_branch Lp_82
Lq_83:
    s_add_u32 s48, s47, 49152
    buffer_load_dwordx4 v[128:131], v12, s[24:27], s48 offen offset:0 nt
    buffer_load_dwordx4 v[132:135], v13, s[24:27], s48 offen offset:1024 nt
    buffer_load_dwordx4 v[136:139], v14, s[24:27], s48 offen offset:2048 nt
    buffer_load_dwordx4 v[140:143], v15, s[24:27], s48 offen offset:3072 nt
    s_add_u32 s48, s47, 53248
    buffer_load_dwordx4 v[144:147], v12, s[24:27], s48 offen offset:0 nt
    buffer_load_dwordx4 v[148:151], v13, s[24:27], s48 offen offset:1024 nt
    buffer_load_dwordx4 v[152:155], v14, s[24:27], s48 offen offset:2048 nt
    buffer_load_dwordx4 v[156:159], v15, s[24:27], s48 offen offset:3072 nt
    s_add_u32 s48, s47, 57344
    buffer_load_dwordx4 v[160:163], v12, s[24:27], s48 offen offset:0 nt
    buffer_load_dwordx4 v[164:167], v13, s[24:27], s48 offen offset:1024 nt
    buffer_load_dwordx4 v[168:171], v14, s[24:27], s48 offen offset:2048 nt
    buffer_load_dwordx4 v[172:175], v15, s[24:27], s48 offen offset:3072 nt
    s_add_u32 s48, s47, 61440
    buffer_load_dwordx4 v[176:179], v12, s[24:27], s48 offen offset:0 nt
    buffer_load_dwordx4 v[180:183], v13, s[24:27], s48 offen offset:1024 nt
    buffer_load_dwordx4 v[184:187], v14, s[24:27], s48 offen offset:2048 nt
    buffer_load_dwordx4 v[188:191], v15, s[24:27], s48 offen offset:3072 nt
    s_waitcnt vmcnt(0)
    s_mov_b64 exec, 1
    ds_add_u32 v6, v7 offset:256
    s_mov_b64 exec, -1
Lp_84:
    ds_read_b32 v5, v6 offset:148
    s_waitcnt lgkmcnt(0)
    v_readfirstlane_b32 s57, v5
    s_cmp_ge_u32 s57, 3
    s_cbranch_scc1 Lq_85
    s_sleep 1
    s_branch Lp_84
Lq_85:
Lp_86:
    ds_read_b32 v5, v6 offset:152
    s_waitcnt lgkmcnt(0)
    v_readfirstlane_b32 s57, v5
    s_cmp_ge_u32 s57, 3
    s_cbranch_scc1 Lq_87
    s_sleep 1
    s_branch Lp_86
Lq_87:
    v_add_u32 v19, 16384, v18
    ds_write_b128 v19, v[64:67] offset:0
    ds_write_b128 v19, v[68:71] offset:1024
    ds_write_b128 v19, v[72:75] offset:2048
    ds_write_b128 v19, v[76:79] offset:3072
    ds_write_b128 v19, v[80:83] offset:4096
    ds_write_b128 v19, v[84:87] offset:5120
    ds_write_b128 v19, v[88:91] offset:6144
    ds_write_b128 v19, v[92:95] offset:7168
    ds_write_b128 v19, v[96:99] offset:8192
    ds_write_b128 v19, v[100:103] offset:9216
    ds_write_b128 v19, v[104:107] offset:10240
    ds_write_b128 v19, v[108:111] offset:11264
    ds_write_b128 v19, v[112:115] offset:12288
    ds_write_b128 v19, v[116:119] offset:13312
    ds_write_b128 v19, v[120:123] offset:14336
    ds_write_b128 v19, v[124:127] offset:15360
    s_waitcnt lgkmcnt(0)
    s_mov_b64 exec, 1
    ds_write_b32 v6, v7 offset:96
    s_mov_b64 exec, -1
Lp_88:
    ds_read_b32 v5, v6 offset:256
    s_waitcnt lgkmcnt(0)
    v_readfirstlane_b32 s57, v5
    s_cmp_ge_u32 s57, 8
    s_cbranch_scc1 Lq_89
    s_sleep 2
    s_branch Lp_88
Lq_89:
    s_add_u32 s48, s47, 49152
    buffer_load_dwordx4 v[192:195], v11, s[28:31], s48 offen offset:0 nt
    buffer_load_dwordx4 v[196:199], v11, s[28:31], s48 offen offset:1024 nt
    buffer_load_dwordx4 v[200:203], v11, s[28:31], s48 offen offset:2048 nt
    buffer_load_dwordx4 v[204:207], v11, s[28:31], s48 offen offset:3072 nt
    s_add_u32 s48, s47, 53248
    buffer_load_dwordx4 v[208:211], v11, s[28:31], s48 offen offset:0 nt
    buffer_load_dwordx4 v[212:215], v11, s[28:31], s48 offen offset:1024 nt
    buffer_load_dwordx4 v[216:219], v11, s[28:31], s48 offen offset:2048 nt
    buffer_load_dwordx4 v[220:223], v11, s[28:31], s48 offen offset:3072 nt
    s_add_u32 s48, s47, 57344
    buffer_load_dwordx4 v[224:227], v11, s[28:31], s48 offen offset:0 nt
    buffer_load_dwordx4 v[228:231], v11, s[28:31], s48 offen offset:1024 nt
    buffer_load_dwordx4 v[232:235], v11, s[28:31], s48 offen offset:2048 nt
    buffer_load_dwordx4 v[236:239], v11, s[28:31], s48 offen offset:3072 nt
    s_add_u32 s48, s47, 61440
    buffer_load_dwordx4 v[240:243], v11, s[28:31], s48 offen offset:0 nt
    buffer_load_dwordx4 v[244:247], v11, s[28:31], s48 offen offset:1024 nt
    buffer_load_dwordx4 v[248:251], v11, s[28:31], s48 offen offset:2048 nt
    buffer_load_dwordx4 v[252:255], v11, s[28:31], s48 offen offset:3072 nt
Lp_90:
    ds_read_b32 v5, v6 offset:156
    s_waitcnt lgkmcnt(0)
    v_readfirstlane_b32 s57, v5
    s_cmp_ge_u32 s57, 3
    s_cbranch_scc1 Lq_91
    s_sleep 1
    s_branch Lp_90
Lq_91:
Lp_92:
    ds_read_b32 v5, v6 offset:156
    s_waitcnt lgkmcnt(0)
    v_readfirstlane_b32 s57, v5
    s_cmp_ge_u32 s57, 3
    s_cbranch_scc1 Lq_93
    s_sleep 1
    s_branch Lp_92
Lq_93:
    v_add_u32 v19, 65536, v18
    ds_write_b128 v19, v[128:131] offset:0
    ds_write_b128 v19, v[132:135] offset:1024
    ds_write_b128 v19, v[136:139] offset:2048
    ds_write_b128 v19, v[140:143] offset:3072
    ds_write_b128 v19, v[144:147] offset:4096
    ds_write_b128 v19, v[148:151] offset:5120
    ds_write_b128 v19, v[152:155] offset:6144
    ds_write_b128 v19, v[156:159] offset:7168
    ds_write_b128 v19, v[160:163] offset:8192
    ds_write_b128 v19, v[164:167] offset:9216
    ds_write_b128 v19, v[168:171] offset:10240
    ds_write_b128 v19, v[172:175] offset:11264
    ds_write_b128 v19, v[176:179] offset:12288
    ds_write_b128 v19, v[180:183] offset:13312
    ds_write_b128 v19, v[184:187] offset:14336
    ds_write_b128 v19, v[188:191] offset:15360
    s_waitcnt lgkmcnt(0)
    s_mov_b64 exec, 1
    ds_write_b32 v6, v7 offset:76
    s_mov_b64 exec, -1
    s_waitcnt vmcnt(0)
    s_mov_b64 exec, 1
    ds_add_u32 v6, v7 offset:256
    s_mov_b64 exec, -1
Lp_94:
    ds_read_b32 v5, v6 offset:164
    s_waitcnt lgkmcnt(0)
    v_readfirstlane_b32 s57, v5
    s_cmp_ge_u32 s57, 3
    s_cbranch_scc1 Lq_95
    s_sleep 1
    s_branch Lp_94
Lq_95:
    v_add_u32 v19, 114688, v18
    ds_write_b128 v19, v[192:195] offset:0
    ds_write_b128 v19, v[196:199] offset:1024
    ds_write_b128 v19, v[200:203] offset:2048
    ds_write_b128 v19, v[204:207] offset:3072
    ds_write_b128 v19, v[208:211] offset:4096
    ds_write_b128 v19, v[212:215] offset:5120
    ds_write_b128 v19, v[216:219] offset:6144
    ds_write_b128 v19, v[220:223] offset:7168
    ds_write_b128 v19, v[224:227] offset:8192
    ds_write_b128 v19, v[228:231] offset:9216
    ds_write_b128 v19, v[232:235] offset:10240
    ds_write_b128 v19, v[236:239] offset:11264
    ds_write_b128 v19, v[240:243] offset:12288
    ds_write_b128 v19, v[244:247] offset:13312
    ds_write_b128 v19, v[248:251] offset:14336
    ds_write_b128 v19, v[252:255] offset:15360
    s_waitcnt lgkmcnt(0)
    s_mov_b64 exec, 1
    ds_write_b32 v6, v7 offset:108
    s_mov_b64 exec, -1
    s_waitcnt vmcnt(0) lgkmcnt(0)
    s_endpgm
L1_lk2:
    s_waitcnt lgkmcnt(0)
    s_mov_b32 s24, s6
    s_and_b32 s25, s7, 0xffff
    s_mov_b32 s26, 33554432
    s_mov_b32 s27, 0x00020000
    s_mov_b32 s28, s8
    s_and_b32 s29, s9, 0xffff
    s_mov_b32 s30, 33554432
    s_mov_b32 s31, 0x00020000
    s_barrier
Lp_96:
    ds_read_b32 v5, v6 offset:256
    s_waitcnt lgkmcnt(0)
    v_readfirstlane_b32 s57, v5
    s_cmp_ge_u32 s57, 3
    s_cbranch_scc1 Lq_97
    s_sleep 2
    s_branch Lp_96
Lq_97:
    s_add_u32 s48, s47, 32768
    buffer_load_dwordx4 v[64:67], v12, s[24:27], s48 offen offset:0 nt
    buffer_load_dwordx4 v[68:71], v13, s[24:27], s48 offen offset:1024 nt
    buffer_load_dwordx4 v[72:75], v14, s[24:27], s48 offen offset:2048 nt
    buffer_load_dwordx4 v[76:79], v15, s[24:27], s48 offen offset:3072 nt
    s_add_u32 s48, s47, 36864
    buffer_load_dwordx4 v[80:83], v12, s[24:27], s48 offen offset:0 nt
    buffer_load_dwordx4 v[84:87], v13, s[24:27], s48 offen offset:1024 nt
    buffer_load_dwordx4 v[88:91], v14, s[24:27], s48 offen offset:2048 nt
    buffer_load_dwordx4 v[92:95], v15, s[24:27], s48 offen offset:3072 nt
    s_add_u32 s48, s47, 40960
    buffer_load_dwordx4 v[96:99], v12, s[24:27], s48 offen offset:0 nt
    buffer_load_dwordx4 v[100:103], v13, s[24:27], s48 offen offset:1024 nt
    buffer_load_dwordx4 v[104:107], v14, s[24:27], s48 offen offset:2048 nt
    buffer_load_dwordx4 v[108:111], v15, s[24:27], s48 offen offset:3072 nt
    s_add_u32 s48, s47, 45056
    buffer_load_dwordx4 v[112:115], v12, s[24:27], s48 offen offset:0 nt
    buffer_load_dwordx4 v[116:119], v13, s[24:27], s48 offen offset:1024 nt
    buffer_load_dwordx4 v[120:123], v14, s[24:27], s48 offen offset:2048 nt
    buffer_load_dwordx4 v[124:127], v15, s[24:27], s48 offen offset:3072 nt
    s_waitcnt vmcnt(0)
    s_mov_b64 exec, 1
    ds_add_u32 v6, v7 offset:256
    s_mov_b64 exec, -1
Lp_98:
    ds_read_b32 v5, v6 offset:256
    s_waitcnt lgkmcnt(0)
    v_readfirstlane_b32 s57, v5
    s_cmp_ge_u32 s57, 6
    s_cbranch_scc1 Lq_99
    s_sleep 2
    s_branch Lp_98
Lq_99:
    s_add_u32 s48, s47, 32768
    buffer_load_dwordx4 v[128:131], v11, s[28:31], s48 offen offset:0 nt
    buffer_load_dwordx4 v[132:135], v11, s[28:31], s48 offen offset:1024 nt
    buffer_load_dwordx4 v[136:139], v11, s[28:31], s48 offen offset:2048 nt
    buffer_load_dwordx4 v[140:143], v11, s[28:31], s48 offen offset:3072 nt
    s_add_u32 s48, s47, 36864
    buffer_load_dwordx4 v[144:147], v11, s[28:31], s48 offen offset:0 nt
    buffer_load_dwordx4 v[148:151], v11, s[28:31], s48 offen offset:1024 nt
    buffer_load_dwordx4 v[152:155], v11, s[28:31], s48 offen offset:2048 nt
    buffer_load_dwordx4 v[156:159], v11, s[28:31], s48 offen offset:3072 nt
    s_add_u32 s48, s47, 40960
    buffer_load_dwordx4 v[160:163], v11, s[28:31], s48 offen offset:0 nt
    buffer_load_dwordx4 v[164:167], v11, s[28:31], s48 offen offset:1024 nt
    buffer_load_dwordx4 v[168:171], v11, s[28:31], s48 offen offset:2048 nt
    buffer_load_dwordx4 v[172:175], v11, s[28:31], s48 offen offset:3072 nt
    s_add_u32 s48, s47, 45056
    buffer_load_dwordx4 v[176:179], v11, s[28:31], s48 offen offset:0 nt
    buffer_load_dwordx4 v[180:183], v11, s[28:31], s48 offen offset:1024 nt
    buffer_load_dwordx4 v[184:187], v11, s[28:31], s48 offen offset:2048 nt
    buffer_load_dwordx4 v[188:191], v11, s[28:31], s48 offen offset:3072 nt
    s_waitcnt vmcnt(0)
    s_mov_b64 exec, 1
    ds_add_u32 v6, v7 offset:256
    s_mov_b64 exec, -1
Lp_100:
    ds_read_b32 v5, v6 offset:152
    s_waitcnt lgkmcnt(0)
    v_readfirstlane_b32 s57, v5
    s_cmp_ge_u32 s57, 3
    s_cbranch_scc1 Lq_101
    s_sleep 1
    s_branch Lp_100
Lq_101:
Lp_102:
    ds_read_b32 v5, v6 offset:152
    s_waitcnt lgkmcnt(0)
    v_readfirstlane_b32 s57, v5
    s_cmp_ge_u32 s57, 3
    s_cbranch_scc1 Lq_103
    s_sleep 1
    s_branch Lp_102
Lq_103:
    v_add_u32 v19, 32768, v18
    ds_write_b128 v19, v[64:67] offset:0
    ds_write_b128 v19, v[68:71] offset:1024
    ds_write_b128 v19, v[72:75] offset:2048
    ds_write_b128 v19, v[76:79] offset:3072
    ds_write_b128 v19, v[80:83] offset:4096
    ds_write_b128 v19, v[84:87] offset:5120
    ds_write_b128 v19, v[88:91] offset:6144
    ds_write_b128 v19, v[92:95] offset:7168
    ds_write_b128 v19, v[96:99] offset:8192
    ds_write_b128 v19, v[100:103] offset:9216
    ds_write_b128 v19, v[104:107] offset:10240
    ds_write_b128 v19, v[108:111] offset:11264
    ds_write_b128 v19, v[112:115] offset:12288
    ds_write_b128 v19, v[116:119] offset:13312
    ds_write_b128 v19, v[120:123] offset:14336
    ds_write_b128 v19, v[124:127] offset:15360
    s_waitcnt lgkmcnt(0)
    s_mov_b64 exec, 1
    ds_write_b32 v6, v7 offset:72
    s_mov_b64 exec, -1
Lp_104:
    ds_read_b32 v5, v6 offset:256
    s_waitcnt lgkmcnt(0)
    v_readfirstlane_b32 s57, v5
    s_cmp_ge_u32 s57, 9
    s_cbranch_scc1 Lq_105
    s_sleep 2
    s_branch Lp_104
Lq_105:
    s_add_u32 s48, s47, 81920
    buffer_load_dwordx4 v[192:195], v12, s[24:27], s48 offen offset:0 nt
    buffer_load_dwordx4 v[196:199], v13, s[24:27], s48 offen offset:1024 nt
    buffer_load_dwordx4 v[200:203], v14, s[24:27], s48 offen offset:2048 nt
    buffer_load_dwordx4 v[204:207], v15, s[24:27], s48 offen offset:3072 nt
    s_add_u32 s48, s47, 86016
    buffer_load_dwordx4 v[208:211], v12, s[24:27], s48 offen offset:0 nt
    buffer_load_dwordx4 v[212:215], v13, s[24:27], s48 offen offset:1024 nt
    buffer_load_dwordx4 v[216:219], v14, s[24:27], s48 offen offset:2048 nt
    buffer_load_dwordx4 v[220:223], v15, s[24:27], s48 offen offset:3072 nt
    s_add_u32 s48, s47, 90112
    buffer_load_dwordx4 v[224:227], v12, s[24:27], s48 offen offset:0 nt
    buffer_load_dwordx4 v[228:231], v13, s[24:27], s48 offen offset:1024 nt
    buffer_load_dwordx4 v[232:235], v14, s[24:27], s48 offen offset:2048 nt
    buffer_load_dwordx4 v[236:239], v15, s[24:27], s48 offen offset:3072 nt
    s_add_u32 s48, s47, 94208
    buffer_load_dwordx4 v[240:243], v12, s[24:27], s48 offen offset:0 nt
    buffer_load_dwordx4 v[244:247], v13, s[24:27], s48 offen offset:1024 nt
    buffer_load_dwordx4 v[248:251], v14, s[24:27], s48 offen offset:2048 nt
    buffer_load_dwordx4 v[252:255], v15, s[24:27], s48 offen offset:3072 nt
Lp_106:
    ds_read_b32 v5, v6 offset:156
    s_waitcnt lgkmcnt(0)
    v_readfirstlane_b32 s57, v5
    s_cmp_ge_u32 s57, 3
    s_cbranch_scc1 Lq_107
    s_sleep 1
    s_branch Lp_106
Lq_107:
Lp_108:
    ds_read_b32 v5, v6 offset:160
    s_waitcnt lgkmcnt(0)
    v_readfirstlane_b32 s57, v5
    s_cmp_ge_u32 s57, 3
    s_cbranch_scc1 Lq_109
    s_sleep 1
    s_branch Lp_108
Lq_109:
    v_add_u32 v19, 81920, v18
    ds_write_b128 v19, v[128:131] offset:0
    ds_write_b128 v19, v[132:135] offset:1024
    ds_write_b128 v19, v[136:139] offset:2048
    ds_write_b128 v19, v[140:143] offset:3072
    ds_write_b128 v19, v[144:147] offset:4096
    ds_write_b128 v19, v[148:151] offset:5120
    ds_write_b128 v19, v[152:155] offset:6144
    ds_write_b128 v19, v[156:159] offset:7168
    ds_write_b128 v19, v[160:163] offset:8192
    ds_write_b128 v19, v[164:167] offset:9216
    ds_write_b128 v19, v[168:171] offset:10240
    ds_write_b128 v19, v[172:175] offset:11264
    ds_write_b128 v19, v[176:179] offset:12288
    ds_write_b128 v19, v[180:183] offset:13312
    ds_write_b128 v19, v[184:187] offset:14336
    ds_write_b128 v19, v[188:191] offset:15360
    s_waitcnt lgkmcnt(0)
    s_mov_b64 exec, 1
    ds_write_b32 v6, v7 offset:104
    s_mov_b64 exec, -1
    s_waitcnt vmcnt(0)
    s_mov_b64 exec, 1
    ds_add_u32 v6, v7 offset:256
    s_mov_b64 exec, -1
Lp_110:
    ds_read_b32 v5, v6 offset:164
    s_waitcnt lgkmcnt(0)
    v_readfirstlane_b32 s57, v5
    s_cmp_ge_u32 s57, 3
    s_cbranch_scc1 Lq_111
    s_sleep 1
    s_branch Lp_110
Lq_111:
Lp_112:
    ds_read_b32 v5, v6 offset:192
    s_waitcnt lgkmcnt(0)
    v_readfirstlane_b32 s57, v5
    s_cmp_ge_u32 s57, 3
    s_cbranch_scc1 Lq_113
    s_sleep 1
    s_branch Lp_112
Lq_113:
    v_add_u32 v19, 131072, v18
    ds_write_b128 v19, v[192:195] offset:0
    ds_write_b128 v19, v[196:199] offset:1024
    ds_write_b128 v19, v[200:203] offset:2048
    ds_write_b128 v19, v[204:207] offset:3072
    ds_write_b128 v19, v[208:211] offset:4096
    ds_write_b128 v19, v[212:215] offset:5120
    ds_write_b128 v19, v[216:219] offset:6144
    ds_write_b128 v19, v[220:223] offset:7168
    ds_write_b128 v19, v[224:227] offset:8192
    ds_write_b128 v19, v[228:231] offset:9216
    ds_write_b128 v19, v[232:235] offset:10240
    ds_write_b128 v19, v[236:239] offset:11264
    ds_write_b128 v19, v[240:243] offset:12288
    ds_write_b128 v19, v[244:247] offset:13312
    ds_write_b128 v19, v[248:251] offset:14336
    ds_write_b128 v19, v[252:255] offset:15360
    s_waitcnt lgkmcnt(0)
    s_mov_b64 exec, 1
    ds_write_b32 v6, v7 offset:84
    s_mov_b64 exec, -1
    s_waitcnt vmcnt(0) lgkmcnt(0)
    s_endpgm
L1_end:
    s_endpgm
.globl oproj_kernel
.p2align 8
.type oproj_kernel,@function
oproj_kernel:
    s_cmp_ge_u32 s2, 240
    s_cbranch_scc1 L2_end
    s_load_dwordx8 s[12:19], s[0:1], 32
    v_lshrrev_b32 v2, 6, v0
    v_and_b32 v1, 63, v0
    s_nop 0
    v_readfirstlane_b32 s40, v2
    s_and_b32 s41, s2, 7
    s_lshr_b32 s42, s2, 3
    s_mul_i32 s43, s42, 52
    s_lshr_b32 s43, s43, 8
    s_mul_i32 s44, s43, 5
    s_sub_u32 s44, s42, s44
    s_lshr_b32 s45, s41, 1
    s_mul_i32 s52, s45, 6
    s_add_u32 s45, s52, s43
    s_and_b32 s46, s41, 1
    s_mul_i32 s53, s46, 5
    s_add_u32 s46, s53, s44
    v_lshrrev_b32 v2, 3, v1
    v_mul_u32_u24 v2, 1280, v2
    v_bfe_u32 v3, v1, 4, 1
    v_lshlrev_b32 v3, 2, v3
    v_and_b32 v4, 7, v1
    v_xor_b32 v3, v3, v4
    v_lshl_add_u32 v10, v3, 4, v2
    v_lshlrev_b32 v11, 4, v1
    v_lshrrev_b32 v2, 5, v1
    v_bfe_u32 v3, v1, 2, 2
    v_and_b32 v4, 3, v1
    v_bfe_u32 v5, v1, 4, 1
    v_lshl_add_u32 v7, v2, 2, v3
    v_lshlrev_b32 v7, 7, v7
    v_lshl_add_u32 v7, v5, 5, v7
    v_lshl_add_u32 v7, v4, 3, v7
    s_mul_i32 s47, s40, 16384
    v_add_u32 v7, s47, v7
    v_lshrrev_b32 v8, 1, v3
    v_lshl_add_u32 v12, v8, 6, v7
    v_xor_b32 v8, 1, v8
    v_lshl_add_u32 v13, v8, 6, v7
    s_mul_i32 s48, s40, 40960
    s_lshl_b32 s49, s46, 7
    s_add_u32 s48, s48, s49
    s_lshl_b32 s49, s45, 18
    s_lshl_b32 s50, s40, 11
    s_add_u32 s49, s49, s50
    v_mov_b32 v24, 0
    v_mov_b32 v25, 0
    v_mov_b32 v26, 0
    v_mov_b32 v27, 0
    v_mov_b32 v28, 0
    v_mov_b32 v29, 0
    v_mov_b32 v30, 0
    v_mov_b32 v31, 0
    v_mov_b32 v32, 0
    v_mov_b32 v33, 0
    v_mov_b32 v34, 0
    v_mov_b32 v35, 0
    v_mov_b32 v36, 0
    v_mov_b32 v37, 0
    v_mov_b32 v38, 0
    v_mov_b32 v39, 0
    v_mov_b32 v40, 0
    v_mov_b32 v41, 0
    v_mov_b32 v42, 0
    v_mov_b32 v43, 0
    v_mov_b32 v44, 0
    v_mov_b32 v45, 0
    v_mov_b32 v46, 0
    v_mov_b32 v47, 0
    v_mov_b32 v48, 0
    v_mov_b32 v49, 0
    v_mov_b32 v50, 0
    v_mov_b32 v51, 0
    v_mov_b32 v52, 0
    v_mov_b32 v53, 0
    v_mov_b32 v54, 0
    v_mov_b32 v55, 0
    s_mul_i32 s54, s43, 3
    s_mul_i32 s55, s44, 0
    s_add_u32 s54, s54, s55
    s_and_b32 s54, s54, 15
    s_mul_i32 s55, s54, 327680
    s_add_u32 s55, s55, s48
    s_add_u32 m0, s47, 0
    s_add_u32 s51, s55, 0
    s_waitcnt lgkmcnt(0)
    s_mov_b32 s20, s12
    s_and_b32 s21, s13, 0xffff
    s_mov_b32 s22, 5242880
    s_mov_b32 s23, 0x00020000
    s_mov_b32 s24, s14
    s_and_b32 s25, s15, 0xffff
    s_mov_b32 s26, 983040
    s_mov_b32 s27, 0x00020000
    s_mov_b32 s28, s18
    s_and_b32 s29, s19, 0xffff
    s_mov_b32 s30, 6291456
    s_mov_b32 s31, 0x00020000
    buffer_load_dwordx4 v10, s[20:23], s51 offen  lds
    s_add_u32 m0, s47, 1024
    s_add_u32 s51, s55, 10240
    buffer_load_dwordx4 v10, s[20:23], s51 offen  lds
    s_add_u32 m0, s47, 2048
    s_add_u32 s51, s55, 20480
    buffer_load_dwordx4 v10, s[20:23], s51 offen  lds
    s_add_u32 m0, s47, 3072
    s_add_u32 s51, s55, 30720
    buffer_load_dwordx4 v10, s[20:23], s51 offen  lds
    s_lshl_b32 s51, s54, 14
    s_add_u32 s51, s51, s49
    s_add_u32 s54, s54, 1
    s_and_b32 s54, s54, 15
    buffer_load_dwordx4 v[56:59], v11, s[28:31], s51 offen
    buffer_load_dwordx4 v[60:63], v11, s[28:31], s51 offen offset:1024
    s_mul_i32 s55, s54, 327680
    s_add_u32 s55, s55, s48
    s_add_u32 m0, s47, 4096
    s_add_u32 s51, s55, 0
    buffer_load_dwordx4 v10, s[20:23], s51 offen  lds
    s_add_u32 m0, s47, 5120
    s_add_u32 s51, s55, 10240
    buffer_load_dwordx4 v10, s[20:23], s51 offen  lds
    s_add_u32 m0, s47, 6144
    s_add_u32 s51, s55, 20480
    buffer_load_dwordx4 v10, s[20:23], s51 offen  lds
    s_add_u32 m0, s47, 7168
    s_add_u32 s51, s55, 30720
    buffer_load_dwordx4 v10, s[20:23], s51 offen  lds
    s_lshl_b32 s51, s54, 14
    s_add_u32 s51, s51, s49
    s_add_u32 s54, s54, 1
    s_and_b32 s54, s54, 15
    buffer_load_dwordx4 v[64:67], v11, s[28:31], s51 offen
    buffer_load_dwordx4 v[68:71], v11, s[28:31], s51 offen offset:1024
    s_mul_i32 s55, s54, 327680
    s_add_u32 s55, s55, s48
    s_add_u32 m0, s47, 8192
    s_add_u32 s51, s55, 0
    buffer_load_dwordx4 v10, s[20:23], s51 offen  lds
    s_add_u32 m0, s47, 9216
    s_add_u32 s51, s55, 10240
    buffer_load_dwordx4 v10, s[20:23], s51 offen  lds
    s_add_u32 m0, s47, 10240
    s_add_u32 s51, s55, 20480
    buffer_load_dwordx4 v10, s[20:23], s51 offen  lds
    s_add_u32 m0, s47, 11264
    s_add_u32 s51, s55, 30720
    buffer_load_dwordx4 v10, s[20:23], s51 offen  lds
    s_lshl_b32 s51, s54, 14
    s_add_u32 s51, s51, s49
    s_add_u32 s54, s54, 1
    s_and_b32 s54, s54, 15
    buffer_load_dwordx4 v[72:75], v11, s[28:31], s51 offen
    buffer_load_dwordx4 v[76:79], v11, s[28:31], s51 offen offset:1024
    s_mul_i32 s55, s54, 327680
    s_add_u32 s55, s55, s48
    s_add_u32 m0, s47, 12288
    s_add_u32 s51, s55, 0
    buffer_load_dwordx4 v10, s[20:23], s51 offen  lds
    s_add_u32 m0, s47, 13312
    s_add_u32 s51, s55, 10240
    buffer_load_dwordx4 v10, s[20:23], s51 offen  lds
    s_add_u32 m0, s47, 14336
    s_add_u32 s51, s55, 20480
    buffer_load_dwordx4 v10, s[20:23], s51 offen  lds
    s_add_u32 m0, s47, 15360
    s_add_u32 s51, s55, 30720
    buffer_load_dwordx4 v10, s[20:23], s51 offen  lds
    s_lshl_b32 s51, s54, 14
    s_add_u32 s51, s51, s49
    s_add_u32 s54, s54, 1
    s_and_b32 s54, s54, 15
    buffer_load_dwordx4 v[80:83], v11, s[28:31], s51 offen
    buffer_load_dwordx4 v[84:87], v11, s[28:31], s51 offen offset:1024
    s_waitcnt vmcnt(18)
    ds_read_b64_tr_b16 v[88:89], v12 offset:0
    ds_read_b64_tr_b16 v[90:91], v12 offset:1024
    ds_read_b64_tr_b16 v[92:93], v13 offset:0
    ds_read_b64_tr_b16 v[94:95], v13 offset:1024
    ds_read_b64_tr_b16 v[96:97], v12 offset:2048
    ds_read_b64_tr_b16 v[98:99], v12 offset:3072
    ds_read_b64_tr_b16 v[100:101], v13 offset:2048
    ds_read_b64_tr_b16 v[102:103], v13 offset:3072
    s_waitcnt lgkmcnt(6)
    v_mfma_f32_32x32x16_bf16 v[24:39], v[88:91], v[56:59], v[24:39]
    s_waitcnt lgkmcnt(4)
    v_mfma_f32_32x32x16_bf16 v[40:55], v[92:95], v[56:59], v[40:55]
    s_waitcnt lgkmcnt(2)
    v_mfma_f32_32x32x16_bf16 v[24:39], v[96:99], v[60:63], v[24:39]
    s_waitcnt lgkmcnt(0)
    v_mfma_f32_32x32x16_bf16 v[40:55], v[100:103], v[60:63], v[40:55]
    s_mul_i32 s55, s54, 327680
    s_add_u32 s55, s55, s48
    s_add_u32 m0, s47, 0
    s_add_u32 s51, s55, 0
    buffer_load_dwordx4 v10, s[20:23], s51 offen  lds
    s_add_u32 m0, s47, 1024
    s_add_u32 s51, s55, 10240
    buffer_load_dwordx4 v10, s[20:23], s51 offen  lds
    s_add_u32 m0, s47, 2048
    s_add_u32 s51, s55, 20480
    buffer_load_dwordx4 v10, s[20:23], s51 offen  lds
    s_add_u32 m0, s47, 3072
    s_add_u32 s51, s55, 30720
    buffer_load_dwordx4 v10, s[20:23], s51 offen  lds
    s_lshl_b32 s51, s54, 14
    s_add_u32 s51, s51, s49
    s_add_u32 s54, s54, 1
    s_and_b32 s54, s54, 15
    buffer_load_dwordx4 v[56:59], v11, s[28:31], s51 offen
    buffer_load_dwordx4 v[60:63], v11, s[28:31], s51 offen offset:1024
    s_waitcnt vmcnt(18)
    ds_read_b64_tr_b16 v[88:89], v12 offset:4096
    ds_read_b64_tr_b16 v[90:91], v12 offset:5120
    ds_read_b64_tr_b16 v[92:93], v13 offset:4096
    ds_read_b64_tr_b16 v[94:95], v13 offset:5120
    ds_read_b64_tr_b16 v[96:97], v12 offset:6144
    ds_read_b64_tr_b16 v[98:99], v12 offset:7168
    ds_read_b64_tr_b16 v[100:101], v13 offset:6144
    ds_read_b64_tr_b16 v[102:103], v13 offset:7168
    s_waitcnt lgkmcnt(6)
    v_mfma_f32_32x32x16_bf16 v[24:39], v[88:91], v[64:67], v[24:39]
    s_waitcnt lgkmcnt(4)
    v_mfma_f32_32x32x16_bf16 v[40:55], v[92:95], v[64:67], v[40:55]
    s_waitcnt lgkmcnt(2)
    v_mfma_f32_32x32x16_bf16 v[24:39], v[96:99], v[68:71], v[24:39]
    s_waitcnt lgkmcnt(0)
    v_mfma_f32_32x32x16_bf16 v[40:55], v[100:103], v[68:71], v[40:55]
    s_mul_i32 s55, s54, 327680
    s_add_u32 s55, s55, s48
    s_add_u32 m0, s47, 4096
    s_add_u32 s51, s55, 0
    buffer_load_dwordx4 v10, s[20:23], s51 offen  lds
    s_add_u32 m0, s47, 5120
    s_add_u32 s51, s55, 10240
    buffer_load_dwordx4 v10, s[20:23], s51 offen  lds
    s_add_u32 m0, s47, 6144
    s_add_u32 s51, s55, 20480
    buffer_load_dwordx4 v10, s[20:23], s51 offen  lds
    s_add_u32 m0, s47, 7168
    s_add_u32 s51, s55, 30720
    buffer_load_dwordx4 v10, s[20:23], s51 offen  lds
    s_lshl_b32 s51, s54, 14
    s_add_u32 s51, s51, s49
    s_add_u32 s54, s54, 1
    s_and_b32 s54, s54, 15
    buffer_load_dwordx4 v[64:67], v11, s[28:31], s51 offen
    buffer_load_dwordx4 v[68:71], v11, s[28:31], s51 offen offset:1024
    s_waitcnt vmcnt(18)
    ds_read_b64_tr_b16 v[88:89], v12 offset:8192
    ds_read_b64_tr_b16 v[90:91], v12 offset:9216
    ds_read_b64_tr_b16 v[92:93], v13 offset:8192
    ds_read_b64_tr_b16 v[94:95], v13 offset:9216
    ds_read_b64_tr_b16 v[96:97], v12 offset:10240
    ds_read_b64_tr_b16 v[98:99], v12 offset:11264
    ds_read_b64_tr_b16 v[100:101], v13 offset:10240
    ds_read_b64_tr_b16 v[102:103], v13 offset:11264
    s_waitcnt lgkmcnt(6)
    v_mfma_f32_32x32x16_bf16 v[24:39], v[88:91], v[72:75], v[24:39]
    s_waitcnt lgkmcnt(4)
    v_mfma_f32_32x32x16_bf16 v[40:55], v[92:95], v[72:75], v[40:55]
    s_waitcnt lgkmcnt(2)
    v_mfma_f32_32x32x16_bf16 v[24:39], v[96:99], v[76:79], v[24:39]
    s_waitcnt lgkmcnt(0)
    v_mfma_f32_32x32x16_bf16 v[40:55], v[100:103], v[76:79], v[40:55]
    s_mul_i32 s55, s54, 327680
    s_add_u32 s55, s55, s48
    s_add_u32 m0, s47, 8192
    s_add_u32 s51, s55, 0
    buffer_load_dwordx4 v10, s[20:23], s51 offen  lds
    s_add_u32 m0, s47, 9216
    s_add_u32 s51, s55, 10240
    buffer_load_dwordx4 v10, s[20:23], s51 offen  lds
    s_add_u32 m0, s47, 10240
    s_add_u32 s51, s55, 20480
    buffer_load_dwordx4 v10, s[20:23], s51 offen  lds
    s_add_u32 m0, s47, 11264
    s_add_u32 s51, s55, 30720
    buffer_load_dwordx4 v10, s[20:23], s51 offen  lds
    s_lshl_b32 s51, s54, 14
    s_add_u32 s51, s51, s49
    s_add_u32 s54, s54, 1
    s_and_b32 s54, s54, 15
    buffer_load_dwordx4 v[72:75], v11, s[28:31], s51 offen
    buffer_load_dwordx4 v[76:79], v11, s[28:31], s51 offen offset:1024
    s_waitcnt vmcnt(18)
    ds_read_b64_tr_b16 v[88:89], v12 offset:12288
    ds_read_b64_tr_b16 v[90:91], v12 offset:13312
    ds_read_b64_tr_b16 v[92:93], v13 offset:12288
    ds_read_b64_tr_b16 v[94:95], v13 offset:13312
    ds_read_b64_tr_b16 v[96:97], v12 offset:14336
    ds_read_b64_tr_b16 v[98:99], v12 offset:15360
    ds_read_b64_tr_b16 v[100:101], v13 offset:14336
    ds_read_b64_tr_b16 v[102:103], v13 offset:15360
    s_waitcnt lgkmcnt(6)
    v_mfma_f32_32x32x16_bf16 v[24:39], v[88:91], v[80:83], v[24:39]
    s_waitcnt lgkmcnt(4)
    v_mfma_f32_32x32x16_bf16 v[40:55], v[92:95], v[80:83], v[40:55]
    s_waitcnt lgkmcnt(2)
    v_mfma_f32_32x32x16_bf16 v[24:39], v[96:99], v[84:87], v[24:39]
    s_waitcnt lgkmcnt(0)
    v_mfma_f32_32x32x16_bf16 v[40:55], v[100:103], v[84:87], v[40:55]
    s_mul_i32 s55, s54, 327680
    s_add_u32 s55, s55, s48
    s_add_u32 m0, s47, 12288
    s_add_u32 s51, s55, 0
    buffer_load_dwordx4 v10, s[20:23], s51 offen  lds
    s_add_u32 m0, s47, 13312
    s_add_u32 s51, s55, 10240
    buffer_load_dwordx4 v10, s[20:23], s51 offen  lds
    s_add_u32 m0, s47, 14336
    s_add_u32 s51, s55, 20480
    buffer_load_dwordx4 v10, s[20:23], s51 offen  lds
    s_add_u32 m0, s47, 15360
    s_add_u32 s51, s55, 30720
    buffer_load_dwordx4 v10, s[20:23], s51 offen  lds
    s_lshl_b32 s51, s54, 14
    s_add_u32 s51, s51, s49
    s_add_u32 s54, s54, 1
    s_and_b32 s54, s54, 15
    buffer_load_dwordx4 v[80:83], v11, s[28:31], s51 offen
    buffer_load_dwordx4 v[84:87], v11, s[28:31], s51 offen offset:1024
    s_waitcnt vmcnt(18)
    ds_read_b64_tr_b16 v[88:89], v12 offset:0
    ds_read_b64_tr_b16 v[90:91], v12 offset:1024
    ds_read_b64_tr_b16 v[92:93], v13 offset:0
    ds_read_b64_tr_b16 v[94:95], v13 offset:1024
    ds_read_b64_tr_b16 v[96:97], v12 offset:2048
    ds_read_b64_tr_b16 v[98:99], v12 offset:3072
    ds_read_b64_tr_b16 v[100:101], v13 offset:2048
    ds_read_b64_tr_b16 v[102:103], v13 offset:3072
    s_waitcnt lgkmcnt(6)
    v_mfma_f32_32x32x16_bf16 v[24:39], v[88:91], v[56:59], v[24:39]
    s_waitcnt lgkmcnt(4)
    v_mfma_f32_32x32x16_bf16 v[40:55], v[92:95], v[56:59], v[40:55]
    s_waitcnt lgkmcnt(2)
    v_mfma_f32_32x32x16_bf16 v[24:39], v[96:99], v[60:63], v[24:39]
    s_waitcnt lgkmcnt(0)
    v_mfma_f32_32x32x16_bf16 v[40:55], v[100:103], v[60:63], v[40:55]
    s_mul_i32 s55, s54, 327680
    s_add_u32 s55, s55, s48
    s_add_u32 m0, s47, 0
    s_add_u32 s51, s55, 0
    buffer_load_dwordx4 v10, s[20:23], s51 offen  lds
    s_add_u32 m0, s47, 1024
    s_add_u32 s51, s55, 10240
    buffer_load_dwordx4 v10, s[20:23], s51 offen  lds
    s_add_u32 m0, s47, 2048
    s_add_u32 s51, s55, 20480
    buffer_load_dwordx4 v10, s[20:23], s51 offen  lds
    s_add_u32 m0, s47, 3072
    s_add_u32 s51, s55, 30720
    buffer_load_dwordx4 v10, s[20:23], s51 offen  lds
    s_lshl_b32 s51, s54, 14
    s_add_u32 s51, s51, s49
    s_add_u32 s54, s54, 1
    s_and_b32 s54, s54, 15
    buffer_load_dwordx4 v[56:59], v11, s[28:31], s51 offen
    buffer_load_dwordx4 v[60:63], v11, s[28:31], s51 offen offset:1024
    s_waitcnt vmcnt(18)
    ds_read_b64_tr_b16 v[88:89], v12 offset:4096
    ds_read_b64_tr_b16 v[90:91], v12 offset:5120
    ds_read_b64_tr_b16 v[92:93], v13 offset:4096
    ds_read_b64_tr_b16 v[94:95], v13 offset:5120
    ds_read_b64_tr_b16 v[96:97], v12 offset:6144
    ds_read_b64_tr_b16 v[98:99], v12 offset:7168
    ds_read_b64_tr_b16 v[100:101], v13 offset:6144
    ds_read_b64_tr_b16 v[102:103], v13 offset:7168
    s_waitcnt lgkmcnt(6)
    v_mfma_f32_32x32x16_bf16 v[24:39], v[88:91], v[64:67], v[24:39]
    s_waitcnt lgkmcnt(4)
    v_mfma_f32_32x32x16_bf16 v[40:55], v[92:95], v[64:67], v[40:55]
    s_waitcnt lgkmcnt(2)
    v_mfma_f32_32x32x16_bf16 v[24:39], v[96:99], v[68:71], v[24:39]
    s_waitcnt lgkmcnt(0)
    v_mfma_f32_32x32x16_bf16 v[40:55], v[100:103], v[68:71], v[40:55]
    s_mul_i32 s55, s54, 327680
    s_add_u32 s55, s55, s48
    s_add_u32 m0, s47, 4096
    s_add_u32 s51, s55, 0
    buffer_load_dwordx4 v10, s[20:23], s51 offen  lds
    s_add_u32 m0, s47, 5120
    s_add_u32 s51, s55, 10240
    buffer_load_dwordx4 v10, s[20:23], s51 offen  lds
    s_add_u32 m0, s47, 6144
    s_add_u32 s51, s55, 20480
    buffer_load_dwordx4 v10, s[20:23], s51 offen  lds
    s_add_u32 m0, s47, 7168
    s_add_u32 s51, s55, 30720
    buffer_load_dwordx4 v10, s[20:23], s51 offen  lds
    s_lshl_b32 s51, s54, 14
    s_add_u32 s51, s51, s49
    s_add_u32 s54, s54, 1
    s_and_b32 s54, s54, 15
    buffer_load_dwordx4 v[64:67], v11, s[28:31], s51 offen
    buffer_load_dwordx4 v[68:71], v11, s[28:31], s51 offen offset:1024
    s_waitcnt vmcnt(18)
    ds_read_b64_tr_b16 v[88:89], v12 offset:8192
    ds_read_b64_tr_b16 v[90:91], v12 offset:9216
    ds_read_b64_tr_b16 v[92:93], v13 offset:8192
    ds_read_b64_tr_b16 v[94:95], v13 offset:9216
    ds_read_b64_tr_b16 v[96:97], v12 offset:10240
    ds_read_b64_tr_b16 v[98:99], v12 offset:11264
    ds_read_b64_tr_b16 v[100:101], v13 offset:10240
    ds_read_b64_tr_b16 v[102:103], v13 offset:11264
    s_waitcnt lgkmcnt(6)
    v_mfma_f32_32x32x16_bf16 v[24:39], v[88:91], v[72:75], v[24:39]
    s_waitcnt lgkmcnt(4)
    v_mfma_f32_32x32x16_bf16 v[40:55], v[92:95], v[72:75], v[40:55]
    s_waitcnt lgkmcnt(2)
    v_mfma_f32_32x32x16_bf16 v[24:39], v[96:99], v[76:79], v[24:39]
    s_waitcnt lgkmcnt(0)
    v_mfma_f32_32x32x16_bf16 v[40:55], v[100:103], v[76:79], v[40:55]
    s_mul_i32 s55, s54, 327680
    s_add_u32 s55, s55, s48
    s_add_u32 m0, s47, 8192
    s_add_u32 s51, s55, 0
    buffer_load_dwordx4 v10, s[20:23], s51 offen  lds
    s_add_u32 m0, s47, 9216
    s_add_u32 s51, s55, 10240
    buffer_load_dwordx4 v10, s[20:23], s51 offen  lds
    s_add_u32 m0, s47, 10240
    s_add_u32 s51, s55, 20480
    buffer_load_dwordx4 v10, s[20:23], s51 offen  lds
    s_add_u32 m0, s47, 11264
    s_add_u32 s51, s55, 30720
    buffer_load_dwordx4 v10, s[20:23], s51 offen  lds
    s_lshl_b32 s51, s54, 14
    s_add_u32 s51, s51, s49
    s_add_u32 s54, s54, 1
    s_and_b32 s54, s54, 15
    buffer_load_dwordx4 v[72:75], v11, s[28:31], s51 offen
    buffer_load_dwordx4 v[76:79], v11, s[28:31], s51 offen offset:1024
    s_waitcnt vmcnt(18)
    ds_read_b64_tr_b16 v[88:89], v12 offset:12288
    ds_read_b64_tr_b16 v[90:91], v12 offset:13312
    ds_read_b64_tr_b16 v[92:93], v13 offset:12288
    ds_read_b64_tr_b16 v[94:95], v13 offset:13312
    ds_read_b64_tr_b16 v[96:97], v12 offset:14336
    ds_read_b64_tr_b16 v[98:99], v12 offset:15360
    ds_read_b64_tr_b16 v[100:101], v13 offset:14336
    ds_read_b64_tr_b16 v[102:103], v13 offset:15360
    s_waitcnt lgkmcnt(6)
    v_mfma_f32_32x32x16_bf16 v[24:39], v[88:91], v[80:83], v[24:39]
    s_waitcnt lgkmcnt(4)
    v_mfma_f32_32x32x16_bf16 v[40:55], v[92:95], v[80:83], v[40:55]
    s_waitcnt lgkmcnt(2)
    v_mfma_f32_32x32x16_bf16 v[24:39], v[96:99], v[84:87], v[24:39]
    s_waitcnt lgkmcnt(0)
    v_mfma_f32_32x32x16_bf16 v[40:55], v[100:103], v[84:87], v[40:55]
    s_mul_i32 s55, s54, 327680
    s_add_u32 s55, s55, s48
    s_add_u32 m0, s47, 12288
    s_add_u32 s51, s55, 0
    buffer_load_dwordx4 v10, s[20:23], s51 offen  lds
    s_add_u32 m0, s47, 13312
    s_add_u32 s51, s55, 10240
    buffer_load_dwordx4 v10, s[20:23], s51 offen  lds
    s_add_u32 m0, s47, 14336
    s_add_u32 s51, s55, 20480
    buffer_load_dwordx4 v10, s[20:23], s51 offen  lds
    s_add_u32 m0, s47, 15360
    s_add_u32 s51, s55, 30720
    buffer_load_dwordx4 v10, s[20:23], s51 offen  lds
    s_lshl_b32 s51, s54, 14
    s_add_u32 s51, s51, s49
    s_add_u32 s54, s54, 1
    s_and_b32 s54, s54, 15
    buffer_load_dwordx4 v[80:83], v11, s[28:31], s51 offen
    buffer_load_dwordx4 v[84:87], v11, s[28:31], s51 offen offset:1024
    s_waitcnt vmcnt(18)
    ds_read_b64_tr_b16 v[88:89], v12 offset:0
    ds_read_b64_tr_b16 v[90:91], v12 offset:1024
    ds_read_b64_tr_b16 v[92:93], v13 offset:0
    ds_read_b64_tr_b16 v[94:95], v13 offset:1024
    ds_read_b64_tr_b16 v[96:97], v12 offset:2048
    ds_read_b64_tr_b16 v[98:99], v12 offset:3072
    ds_read_b64_tr_b16 v[100:101], v13 offset:2048
    ds_read_b64_tr_b16 v[102:103], v13 offset:3072
    s_waitcnt lgkmcnt(6)
    v_mfma_f32_32x32x16_bf16 v[24:39], v[88:91], v[56:59], v[24:39]
    s_waitcnt lgkmcnt(4)
    v_mfma_f32_32x32x16_bf16 v[40:55], v[92:95], v[56:59], v[40:55]
    s_waitcnt lgkmcnt(2)
    v_mfma_f32_32x32x16_bf16 v[24:39], v[96:99], v[60:63], v[24:39]
    s_waitcnt lgkmcnt(0)
    v_mfma_f32_32x32x16_bf16 v[40:55], v[100:103], v[60:63], v[40:55]
    s_mul_i32 s55, s54, 327680
    s_add_u32 s55, s55, s48
    s_add_u32 m0, s47, 0
    s_add_u32 s51, s55, 0
    buffer_load_dwordx4 v10, s[20:23], s51 offen  lds
    s_add_u32 m0, s47, 1024
    s_add_u32 s51, s55, 10240
    buffer_load_dwordx4 v10, s[20:23], s51 offen  lds
    s_add_u32 m0, s47, 2048
    s_add_u32 s51, s55, 20480
    buffer_load_dwordx4 v10, s[20:23], s51 offen  lds
    s_add_u32 m0, s47, 3072
    s_add_u32 s51, s55, 30720
    buffer_load_dwordx4 v10, s[20:23], s51 offen  lds
    s_lshl_b32 s51, s54, 14
    s_add_u32 s51, s51, s49
    s_add_u32 s54, s54, 1
    s_and_b32 s54, s54, 15
    buffer_load_dwordx4 v[56:59], v11, s[28:31], s51 offen
    buffer_load_dwordx4 v[60:63], v11, s[28:31], s51 offen offset:1024
    s_waitcnt vmcnt(18)
    ds_read_b64_tr_b16 v[88:89], v12 offset:4096
    ds_read_b64_tr_b16 v[90:91], v12 offset:5120
    ds_read_b64_tr_b16 v[92:93], v13 offset:4096
    ds_read_b64_tr_b16 v[94:95], v13 offset:5120
    ds_read_b64_tr_b16 v[96:97], v12 offset:6144
    ds_read_b64_tr_b16 v[98:99], v12 offset:7168
    ds_read_b64_tr_b16 v[100:101], v13 offset:6144
    ds_read_b64_tr_b16 v[102:103], v13 offset:7168
    s_waitcnt lgkmcnt(6)
    v_mfma_f32_32x32x16_bf16 v[24:39], v[88:91], v[64:67], v[24:39]
    s_waitcnt lgkmcnt(4)
    v_mfma_f32_32x32x16_bf16 v[40:55], v[92:95], v[64:67], v[40:55]
    s_waitcnt lgkmcnt(2)
    v_mfma_f32_32x32x16_bf16 v[24:39], v[96:99], v[68:71], v[24:39]
    s_waitcnt lgkmcnt(0)
    v_mfma_f32_32x32x16_bf16 v[40:55], v[100:103], v[68:71], v[40:55]
    s_mul_i32 s55, s54, 327680
    s_add_u32 s55, s55, s48
    s_add_u32 m0, s47, 4096
    s_add_u32 s51, s55, 0
    buffer_load_dwordx4 v10, s[20:23], s51 offen  lds
    s_add_u32 m0, s47, 5120
    s_add_u32 s51, s55, 10240
    buffer_load_dwordx4 v10, s[20:23], s51 offen  lds
    s_add_u32 m0, s47, 6144
    s_add_u32 s51, s55, 20480
    buffer_load_dwordx4 v10, s[20:23], s51 offen  lds
    s_add_u32 m0, s47, 7168
    s_add_u32 s51, s55, 30720
    buffer_load_dwordx4 v10, s[20:23], s51 offen  lds
    s_lshl_b32 s51, s54, 14
    s_add_u32 s51, s51, s49
    s_add_u32 s54, s54, 1
    s_and_b32 s54, s54, 15
    buffer_load_dwordx4 v[64:67], v11, s[28:31], s51 offen
    buffer_load_dwordx4 v[68:71], v11, s[28:31], s51 offen offset:1024
    s_waitcnt vmcnt(18)
    ds_read_b64_tr_b16 v[88:89], v12 offset:8192
    ds_read_b64_tr_b16 v[90:91], v12 offset:9216
    ds_read_b64_tr_b16 v[92:93], v13 offset:8192
    ds_read_b64_tr_b16 v[94:95], v13 offset:9216
    ds_read_b64_tr_b16 v[96:97], v12 offset:10240
    ds_read_b64_tr_b16 v[98:99], v12 offset:11264
    ds_read_b64_tr_b16 v[100:101], v13 offset:10240
    ds_read_b64_tr_b16 v[102:103], v13 offset:11264
    s_waitcnt lgkmcnt(6)
    v_mfma_f32_32x32x16_bf16 v[24:39], v[88:91], v[72:75], v[24:39]
    s_waitcnt lgkmcnt(4)
    v_mfma_f32_32x32x16_bf16 v[40:55], v[92:95], v[72:75], v[40:55]
    s_waitcnt lgkmcnt(2)
    v_mfma_f32_32x32x16_bf16 v[24:39], v[96:99], v[76:79], v[24:39]
    s_waitcnt lgkmcnt(0)
    v_mfma_f32_32x32x16_bf16 v[40:55], v[100:103], v[76:79], v[40:55]
    s_mul_i32 s55, s54, 327680
    s_add_u32 s55, s55, s48
    s_add_u32 m0, s47, 8192
    s_add_u32 s51, s55, 0
    buffer_load_dwordx4 v10, s[20:23], s51 offen  lds
    s_add_u32 m0, s47, 9216
    s_add_u32 s51, s55, 10240
    buffer_load_dwordx4 v10, s[20:23], s51 offen  lds
    s_add_u32 m0, s47, 10240
    s_add_u32 s51, s55, 20480
    buffer_load_dwordx4 v10, s[20:23], s51 offen  lds
    s_add_u32 m0, s47, 11264
    s_add_u32 s51, s55, 30720
    buffer_load_dwordx4 v10, s[20:23], s51 offen  lds
    s_lshl_b32 s51, s54, 14
    s_add_u32 s51, s51, s49
    s_add_u32 s54, s54, 1
    s_and_b32 s54, s54, 15
    buffer_load_dwordx4 v[72:75], v11, s[28:31], s51 offen
    buffer_load_dwordx4 v[76:79], v11, s[28:31], s51 offen offset:1024
    s_waitcnt vmcnt(18)
    ds_read_b64_tr_b16 v[88:89], v12 offset:12288
    ds_read_b64_tr_b16 v[90:91], v12 offset:13312
    ds_read_b64_tr_b16 v[92:93], v13 offset:12288
    ds_read_b64_tr_b16 v[94:95], v13 offset:13312
    ds_read_b64_tr_b16 v[96:97], v12 offset:14336
    ds_read_b64_tr_b16 v[98:99], v12 offset:15360
    ds_read_b64_tr_b16 v[100:101], v13 offset:14336
    ds_read_b64_tr_b16 v[102:103], v13 offset:15360
    s_waitcnt lgkmcnt(6)
    v_mfma_f32_32x32x16_bf16 v[24:39], v[88:91], v[80:83], v[24:39]
    s_waitcnt lgkmcnt(4)
    v_mfma_f32_32x32x16_bf16 v[40:55], v[92:95], v[80:83], v[40:55]
    s_waitcnt lgkmcnt(2)
    v_mfma_f32_32x32x16_bf16 v[24:39], v[96:99], v[84:87], v[24:39]
    s_waitcnt lgkmcnt(0)
    v_mfma_f32_32x32x16_bf16 v[40:55], v[100:103], v[84:87], v[40:55]
    s_mul_i32 s55, s54, 327680
    s_add_u32 s55, s55, s48
    s_add_u32 m0, s47, 12288
    s_add_u32 s51, s55, 0
    buffer_load_dwordx4 v10, s[20:23], s51 offen  lds
    s_add_u32 m0, s47, 13312
    s_add_u32 s51, s55, 10240
    buffer_load_dwordx4 v10, s[20:23], s51 offen  lds
    s_add_u32 m0, s47, 14336
    s_add_u32 s51, s55, 20480
    buffer_load_dwordx4 v10, s[20:23], s51 offen  lds
    s_add_u32 m0, s47, 15360
    s_add_u32 s51, s55, 30720
    buffer_load_dwordx4 v10, s[20:23], s51 offen  lds
    s_lshl_b32 s51, s54, 14
    s_add_u32 s51, s51, s49
    s_add_u32 s54, s54, 1
    s_and_b32 s54, s54, 15
    buffer_load_dwordx4 v[80:83], v11, s[28:31], s51 offen
    buffer_load_dwordx4 v[84:87], v11, s[28:31], s51 offen offset:1024
    s_waitcnt vmcnt(18)
    ds_read_b64_tr_b16 v[88:89], v12 offset:0
    ds_read_b64_tr_b16 v[90:91], v12 offset:1024
    ds_read_b64_tr_b16 v[92:93], v13 offset:0
    ds_read_b64_tr_b16 v[94:95], v13 offset:1024
    ds_read_b64_tr_b16 v[96:97], v12 offset:2048
    ds_read_b64_tr_b16 v[98:99], v12 offset:3072
    ds_read_b64_tr_b16 v[100:101], v13 offset:2048
    ds_read_b64_tr_b16 v[102:103], v13 offset:3072
    s_waitcnt lgkmcnt(6)
    v_mfma_f32_32x32x16_bf16 v[24:39], v[88:91], v[56:59], v[24:39]
    s_waitcnt lgkmcnt(4)
    v_mfma_f32_32x32x16_bf16 v[40:55], v[92:95], v[56:59], v[40:55]
    s_waitcnt lgkmcnt(2)
    v_mfma_f32_32x32x16_bf16 v[24:39], v[96:99], v[60:63], v[24:39]
    s_waitcnt lgkmcnt(0)
    v_mfma_f32_32x32x16_bf16 v[40:55], v[100:103], v[60:63], v[40:55]
    s_waitcnt vmcnt(12)
    ds_read_b64_tr_b16 v[88:89], v12 offset:4096
    ds_read_b64_tr_b16 v[90:91], v12 offset:5120
    ds_read_b64_tr_b16 v[92:93], v13 offset:4096
    ds_read_b64_tr_b16 v[94:95], v13 offset:5120
    ds_read_b64_tr_b16 v[96:97], v12 offset:6144
    ds_read_b64_tr_b16 v[98:99], v12 offset:7168
    ds_read_b64_tr_b16 v[100:101], v13 offset:6144
    ds_read_b64_tr_b16 v[102:103], v13 offset:7168
    s_waitcnt lgkmcnt(6)
    v_mfma_f32_32x32x16_bf16 v[24:39], v[88:91], v[64:67], v[24:39]
    s_waitcnt lgkmcnt(4)
    v_mfma_f32_32x32x16_bf16 v[40:55], v[92:95], v[64:67], v[40:55]
    s_waitcnt lgkmcnt(2)
    v_mfma_f32_32x32x16_bf16 v[24:39], v[96:99], v[68:71], v[24:39]
    s_waitcnt lgkmcnt(0)
    v_mfma_f32_32x32x16_bf16 v[40:55], v[100:103], v[68:71], v[40:55]
    s_waitcnt vmcnt(6)
    ds_read_b64_tr_b16 v[88:89], v12 offset:8192
    ds_read_b64_tr_b16 v[90:91], v12 offset:9216
    ds_read_b64_tr_b16 v[92:93], v13 offset:8192
    ds_read_b64_tr_b16 v[94:95], v13 offset:9216
    ds_read_b64_tr_b16 v[96:97], v12 offset:10240
    ds_read_b64_tr_b16 v[98:99], v12 offset:11264
    ds_read_b64_tr_b16 v[100:101], v13 offset:10240
    ds_read_b64_tr_b16 v[102:103], v13 offset:11264
    s_waitcnt lgkmcnt(6)
    v_mfma_f32_32x32x16_bf16 v[24:39], v[88:91], v[72:75], v[24:39]
    s_waitcnt lgkmcnt(4)
    v_mfma_f32_32x32x16_bf16 v[40:55], v[92:95], v[72:75], v[40:55]
    s_waitcnt lgkmcnt(2)
    v_mfma_f32_32x32x16_bf16 v[24:39], v[96:99], v[76:79], v[24:39]
    s_waitcnt lgkmcnt(0)
    v_mfma_f32_32x32x16_bf16 v[40:55], v[100:103], v[76:79], v[40:55]
    s_waitcnt vmcnt(0)
    ds_read_b64_tr_b16 v[88:89], v12 offset:12288
    ds_read_b64_tr_b16 v[90:91], v12 offset:13312
    ds_read_b64_tr_b16 v[92:93], v13 offset:12288
    ds_read_b64_tr_b16 v[94:95], v13 offset:13312
    ds_read_b64_tr_b16 v[96:97], v12 offset:14336
    ds_read_b64_tr_b16 v[98:99], v12 offset:15360
    ds_read_b64_tr_b16 v[100:101], v13 offset:14336
    ds_read_b64_tr_b16 v[102:103], v13 offset:15360
    s_waitcnt lgkmcnt(6)
    v_mfma_f32_32x32x16_bf16 v[24:39], v[88:91], v[80:83], v[24:39]
    s_waitcnt lgkmcnt(4)
    v_mfma_f32_32x32x16_bf16 v[40:55], v[92:95], v[80:83], v[40:55]
    s_waitcnt lgkmcnt(2)
    v_mfma_f32_32x32x16_bf16 v[24:39], v[96:99], v[84:87], v[24:39]
    s_waitcnt lgkmcnt(0)
    v_mfma_f32_32x32x16_bf16 v[40:55], v[100:103], v[84:87], v[40:55]
    v_add_u32 v2, s47, v11
    s_nop 15
    ds_write_b128 v2, v[24:27] offset:0
    ds_write_b128 v2, v[28:31] offset:1024
    ds_write_b128 v2, v[32:35] offset:2048
    ds_write_b128 v2, v[36:39] offset:3072
    ds_write_b128 v2, v[40:43] offset:4096
    ds_write_b128 v2, v[44:47] offset:5120
    ds_write_b128 v2, v[48:51] offset:6144
    ds_write_b128 v2, v[52:55] offset:7168
    s_waitcnt lgkmcnt(0)
    s_barrier
    s_lshl_b32 s50, s40, 10
    v_add_u32 v2, s50, v11
    v_add_u32 v3, 0x10000, v2
    v_add_u32 v5, 0x20000, v2
    ds_read_b128 v[56:59], v2 offset:0
    ds_read_b128 v[60:63], v2 offset:16384
    ds_read_b128 v[64:67], v2 offset:32768
    ds_read_b128 v[68:71], v2 offset:49152
    ds_read_b128 v[72:75], v3 offset:0
    ds_read_b128 v[76:79], v3 offset:16384
    ds_read_b128 v[80:83], v3 offset:32768
    ds_read_b128 v[84:87], v3 offset:49152
    v_and_b32 v4, 31, v1
    v_mul_u32_u24 v4, 1280, v4
    v_lshrrev_b32 v5, 5, v1
    v_lshl_add_u32 v4, v5, 3, v4
    s_mul_i32 s50, s45, 40960
    s_lshl_b32 s51, s46, 7
    s_add_u32 s50, s50, s51
    s_lshl_b32 s51, s40, 4
    s_add_u32 s50, s50, s51
    s_waitcnt lgkmcnt(6)
    v_add_f32 v56, v56, v60
    v_add_f32 v57, v57, v61
    v_add_f32 v58, v58, v62
    v_add_f32 v59, v59, v63
    s_waitcnt lgkmcnt(5)
    v_add_f32 v56, v56, v64
    v_add_f32 v57, v57, v65
    v_add_f32 v58, v58, v66
    v_add_f32 v59, v59, v67
    s_waitcnt lgkmcnt(4)
    v_add_f32 v56, v56, v68
    v_add_f32 v57, v57, v69
    v_add_f32 v58, v58, v70
    v_add_f32 v59, v59, v71
    s_waitcnt lgkmcnt(3)
    v_add_f32 v56, v56, v72
    v_add_f32 v57, v57, v73
    v_add_f32 v58, v58, v74
    v_add_f32 v59, v59, v75
    s_waitcnt lgkmcnt(2)
    v_add_f32 v56, v56, v76
    v_add_f32 v57, v57, v77
    v_add_f32 v58, v58, v78
    v_add_f32 v59, v59, v79
    s_waitcnt lgkmcnt(1)
    v_add_f32 v56, v56, v80
    v_add_f32 v57, v57, v81
    v_add_f32 v58, v58, v82
    v_add_f32 v59, v59, v83
    s_waitcnt lgkmcnt(0)
    v_add_f32 v56, v56, v84
    v_add_f32 v57, v57, v85
    v_add_f32 v58, v58, v86
    v_add_f32 v59, v59, v87
    v_cvt_pk_bf16_f32 v6, v56, v57
    v_cvt_pk_bf16_f32 v7, v58, v59
    buffer_store_dwordx2 v[6:7], v4, s[24:27], s50 offen
L2_end:
    s_endpgm
.section .rodata,"a"
.p2align 6
.amdhsa_kernel attn_kernel
  .amdhsa_next_free_vgpr 256
  .amdhsa_next_free_sgpr 80
  .amdhsa_accum_offset 256
  .amdhsa_group_segment_fixed_size 0
  .amdhsa_kernarg_size 64
  .amdhsa_user_sgpr_count 2
  .amdhsa_user_sgpr_kernarg_segment_ptr 1
  .amdhsa_system_sgpr_workgroup_id_x 1
.end_amdhsa_kernel
.p2align 6
.amdhsa_kernel oproj_kernel
  .amdhsa_next_free_vgpr 104
  .amdhsa_next_free_sgpr 80
  .amdhsa_accum_offset 104
  .amdhsa_group_segment_fixed_size 0
  .amdhsa_kernarg_size 64
  .amdhsa_user_sgpr_count 2
  .amdhsa_user_sgpr_kernarg_segment_ptr 1
  .amdhsa_system_sgpr_workgroup_id_x 1
.end_amdhsa_kernel
```
